```python
import torch

def _softmax(x, axis=-1):
    return torch.softmax(x, dim=axis)
def _gelu(x):
    return torch.nn.functional.gelu(x, approximate="tanh")
def _silu(x):
    return torch.nn.functional.silu(x)
def _sigmoid(x):
    return torch.sigmoid(x)
def _layernorm(x, axis=-1, eps=1e-5):
    m = x.mean(dim=axis, keepdim=True)
    v = x.var(dim=axis, keepdim=True, unbiased=False)
    return (x - m) / torch.sqrt(v + eps)
def _scatter_add(tgt, idx, src, axis=0):
    return tgt.clone().index_add_(axis, idx, src)
def _segment_sum(src, seg, n):
    out = torch.zeros((n,) + src.shape[1:], dtype=src.dtype)
    return out.index_add_(0, seg, src)
def _pad(x, pw):
    flat = tuple(v for pair in reversed(pw) for v in pair)
    return torch.nn.functional.pad(x, flat)

kernel_name = 'recurrent_scan__sliding_local_dilated__dense_activation_squared_relu__prompt'

def setup_inputs():

    _w = (lambda a: (lambda t: t.to(torch.bfloat16) if t.is_floating_point() else t)(torch.as_tensor(a)))
    def _A_setup():
        B, S, D = 1, 2048, 640
        return {
            "x": _w((lambda *s: torch.randn(*s, dtype=torch.bfloat16) * 0.05)(B, S, D)),
            "wqkv": _w((lambda *s: torch.randn(*s, dtype=torch.bfloat16) * 0.05)(D, 3 * D)),
            "wo": _w((lambda *s: torch.randn(*s, dtype=torch.bfloat16) * 0.05)(D, D)),
        }
    _A_in = _A_setup()

    def _B_setup():
        B, S, D, F = 1, 2048, 640, 1536
        return {
            "x": _w((lambda *s: torch.randn(*s, dtype=torch.bfloat16) * 0.05)(B, S, D)),
            "w1": _w((lambda *s: torch.randn(*s, dtype=torch.bfloat16) * 0.05)(D, F)),
            "b1": _w((lambda *s: torch.randn(*s, dtype=torch.bfloat16) * 0.4)(F)),
            "w2": _w((lambda *s: torch.randn(*s, dtype=torch.bfloat16) * 0.05)(F, D)),
            "b2": _w((lambda *s: torch.randn(*s, dtype=torch.bfloat16) * 1.6)(D)),
        }
    _B_in = _B_setup()

    return {
        "A_x": _A_in["x"],
        "A_wqkv": _A_in["wqkv"],
        "A_wo": _A_in["wo"],
        "B_x": _B_in["x"],
        "B_w1": _B_in["w1"],
        "B_b1": _B_in["b1"],
        "B_w2": _B_in["w2"],
        "B_b2": _B_in["b2"],
    }

def reference(A_x, A_wqkv, A_wo, B_x, B_w1, B_b1, B_w2, B_b2):
    def _A_ref(x, wqkv, wo):
        B, S, D = x.shape
        H = 32; Dh = D // H
        W, dil = 8, 2
        qkv = (lambda x, *d: x.permute(*d))((x @ wqkv).reshape(B, S, 3, H, Dh), 2, 0, 3, 1, 4)
        q, k, v = qkv[0], qkv[1], qkv[2]
        scale = Dh ** -0.5
        pos = torch.arange(S)
        off = torch.arange(W) * dil
        idx = pos[:, None] - off[None, :]
        mask = idx >= 0
        idx_c = torch.where(mask, idx, 0).reshape(-1)
        kg = k[:, :, idx_c, :].reshape(B, H, S, W, Dh)
        vg = v[:, :, idx_c, :].reshape(B, H, S, W, Dh)
        logits = torch.einsum("bhsd,bhswd->bhsw", q, kg) * scale
        logits = torch.where(mask[None, None, :, :], logits, -1e9)
        attn = _softmax(logits, axis=-1)
        o = torch.einsum("bhsw,bhswd->bhsd", attn, vg)
        return (lambda x, *d: x.permute(*d))(o, 0, 2, 1, 3).reshape(B, S, D) @ wo

    def _B_ref(x, w1, b1, w2, b2):
        h = torch.einsum("bsd,df->bsf", x, w1) + b1
        zero = torch.zeros_like(h)
        r = torch.where(h > zero, h, zero)
        h = r * r
        out = torch.einsum("bsf,fd->bsd", h, w2) + b2
        return out

    x = A_x
    xn = _layernorm(x, axis=-1)
    s = _A_ref(xn, A_wqkv, A_wo)
    g = _silu(_B_ref(xn, B_w1, B_b1, B_w2, B_b2))
    return x + s * g
```

```asm
; @launch grid=(256,1,1) block=(512,1,1) lds=163840
.amdgcn_target "amdgcn-amd-amdhsa--gfx950"
.text
.globl recurrent_scan__sliding_local_dilated__dense_activation_squared_relu__prompt_kernel
.p2align 8
.type recurrent_scan__sliding_local_dilated__dense_activation_squared_relu__prompt_kernel,@function
recurrent_scan__sliding_local_dilated__dense_activation_squared_relu__prompt_kernel:
    s_getpc_b64 s[52:53]
    v_lshlrev_b32 v1, 7, v0
    v_min_u32 v1, code_end - recurrent_scan__sliding_local_dilated__dense_activation_squared_relu__prompt_kernel - 8, v1
    s_cmp_ge_u32 s2, 256
    s_cbranch_scc1 k_exit
    global_load_dword v249, v1, s[52:53]
    s_load_dwordx4 s[4:7], s[0:1], 0
    s_load_dwordx4 s[16:19], s[0:1], 32
    s_load_dwordx2 s[20:21], s[0:1], 80
    s_load_dwordx2 s[22:23], s[0:1], 16
    s_load_dwordx8 s[84:91], s[0:1], 48
    v_lshrrev_b32 v1, 6, v0
    v_and_b32 v0, 63, v0
    v_readfirstlane_b32 s32, v1
    s_and_b32 s40, s2, 7
    s_lshr_b32 s39, s2, 3
    s_lshr_b32 s37, s40, 2
    s_and_b32 s38, s40, 3
    s_mov_b32 s41, s39
    s_and_b32 s44, s41, 1
    s_lshl_b32 s34, s38, 1
    s_add_u32 s34, s34, s44
    s_lshl_b32 s45, s37, 1
    s_sub_u32 s45, 20, s45
    s_and_b32 s36, s32, 3
    s_sub_u32 s72, 255, s2
    s_lshl_b32 s81, s40, 5
    s_add_u32 s81, s81, s39
    s_lshr_b32 s46, s39, 3
    s_and_b32 s83, s39, 7
    s_lshl_b32 s82, s40, 2
    s_add_u32 s82, s82, s46
    s_waitcnt lgkmcnt(0)
    s_mov_b32 s8, s4
    s_and_b32 s9, s5, 0xffff
    s_mov_b32 s10, 0x280000
    s_mov_b32 s11, 0x20000
    s_mov_b32 s24, s20
    s_and_b32 s25, s21, 0xffff
    s_mov_b32 s26, 0xb33000
    s_mov_b32 s27, 0x20000
    s_cmp_ge_u32 s41, s45
    s_cbranch_scc1 k_typeB
    s_lshr_b32 s47, s41, 1
    s_mul_i32 s33, s37, 10
    s_add_u32 s33, s33, s47
    s_cmp_lt_u32 s32, 4
    s_cbranch_scc1 k_cA
    s_mov_b32 s48, 0x75207520
    s_mov_b32 s49, 0x20
    s_lshl_b32 s47, s47, 2
    s_lshr_b64 s[48:49], s[48:49], s47
    s_and_b32 s47, s48, 15
    s_mul_i32 s46, s44, 3
    s_add_u32 s35, s47, s46
    s_cmp_ge_u32 s35, 10
    s_cselect_b32 s48, 10, 0
    s_sub_u32 s35, s35, s48
    s_setprio 3
    v_lshrrev_b32 v6, 3, v0
    s_lshl_b32 s50, s36, 3
    v_add_u32 v6, s50, v6
    v_lshrrev_b32 v7, 1, v6
    v_xor_b32 v7, v7, v0
    v_and_b32 v7, 7, v7
    v_lshlrev_b32 v7, 4, v7
    s_mul_i32 s50, s33, 112
    s_sub_u32 s50, s50, 16
    v_add_u32 v6, s50, v6
    s_movk_i32 s51, 0x500
    s_movk_i32 s52, 0x7ff
    v_add_u32 v8, 0, v6
    v_max_i32 v8, 0, v8
    v_min_i32 v8, s52, v8
    v_mad_u32_u24 v1, v8, s51, v7
    v_add_u32 v8, 32, v6
    v_max_i32 v8, 0, v8
    v_min_i32 v8, s52, v8
    v_mad_u32_u24 v2, v8, s51, v7
    v_add_u32 v8, 64, v6
    v_max_i32 v8, 0, v8
    v_min_i32 v8, s52, v8
    v_mad_u32_u24 v3, v8, s51, v7
    v_add_u32 v8, 96, v6
    v_max_i32 v8, 0, v8
    v_min_i32 v8, s52, v8
    v_mad_u32_u24 v4, v8, s51, v7
    v_mul_u32_u24 v6, 0x45, v0
    v_lshrrev_b32 v6, 11, v6
    v_mul_u32_u24 v7, 30, v6
    v_sub_u32 v7, v0, v7
    v_mul_u32_u24 v8, 0x1a, v7
    v_lshrrev_b32 v8, 8, v8
    v_mul_u32_u24 v9, 10, v8
    v_sub_u32 v9, v7, v9
    v_mul_u32_u24 v5, 0xf00, v6
    v_mul_u32_u24 v8, 0x500, v8
    v_lshlrev_b32 v9, 4, v9
    v_add3_u32 v5, v5, v8, v9
    s_mul_i32 s50, s34, 160
    s_mul_i32 s51, s36, 61440
    s_add_u32 s50, s50, s51
    v_add_u32 v5, s50, v5
    s_cmp_eq_u32 s36, 0
    s_cselect_b32 s71, 0xffffff00, -1
    s_lshl_b32 s65, s35, 7
    s_mul_i32 s66, s35, 245760
    s_mov_b32 s61, 0
    s_lshl_b32 s63, s36, 10
    s_mul_i32 s64, s36, 7680
    s_add_u32 s64, s64, 16384
    s_waitcnt lgkmcnt(0)
    s_mov_b32 s8, s4
    s_and_b32 s9, s5, 0xffff
    s_mov_b32 s10, 0x280000
    s_mov_b32 s11, 0x20000
    s_mov_b32 s24, s20
    s_and_b32 s25, s21, 0xffff
    s_mov_b32 s26, 0xb33000
    s_mov_b32 s27, 0x20000
    s_mov_b32 s12, s6
    s_and_b32 s13, s7, 0xffff
    s_mov_b32 s14, 0x258000
    s_mov_b32 s15, 0x20000
    s_mov_b32 s28, s90
    s_and_b32 s29, s91, 0xffff
    s_mov_b32 s30, 0x100
    s_mov_b32 s31, 0x20000
    v_mov_b32 v10, 0
    v_and_b32 v11, 7, v0
    v_lshlrev_b32 v11, 3, v11
    v_add_u32 v11, 0x22c00, v11
    v_lshlrev_b32 v12, 4, v0
    v_mov_b32 v17, 0
    s_mov_b32 s70, 0
ldA_loop_1:
    s_cmp_lt_u32 s70, 2
    s_cbranch_scc1 ldA_in_2
    s_waitcnt vmcnt(12)
    s_barrier
ldA_in_2:
    s_add_u32 s67, s61, s63
    s_add_u32 m0, s67, 0
    s_mov_b32 exec_lo, s71
    buffer_load_dwordx4 v1, s[8:11], s65 offen lds
    s_mov_b32 exec_lo, -1
    s_add_u32 m0, s67, 4096
    s_nop 0
    buffer_load_dwordx4 v2, s[8:11], s65 offen lds
    s_add_u32 m0, s67, 8192
    s_nop 0
    buffer_load_dwordx4 v3, s[8:11], s65 offen lds
    s_add_u32 m0, s67, 12288
    s_nop 0
    buffer_load_dwordx4 v4, s[8:11], s65 offen lds
    s_add_u32 s67, s61, s64
    s_mov_b32 exec_hi, 0x0fffffff
    s_add_u32 s68, s66, 0
    s_add_u32 m0, s67, 0
    s_nop 0
    buffer_load_dwordx4 v5, s[12:15], s68 offen lds
    s_add_u32 s68, s66, 7680
    s_add_u32 m0, s67, 960
    s_nop 0
    buffer_load_dwordx4 v5, s[12:15], s68 offen lds
    s_add_u32 s68, s66, 30720
    s_add_u32 m0, s67, 1920
    s_nop 0
    buffer_load_dwordx4 v5, s[12:15], s68 offen lds
    s_add_u32 s68, s66, 38400
    s_add_u32 m0, s67, 2880
    s_nop 0
    buffer_load_dwordx4 v5, s[12:15], s68 offen lds
    s_add_u32 s68, s66, 15360
    s_add_u32 m0, s67, 3840
    s_nop 0
    buffer_load_dwordx4 v5, s[12:15], s68 offen lds
    s_add_u32 s68, s66, 23040
    s_add_u32 m0, s67, 4800
    s_nop 0
    buffer_load_dwordx4 v5, s[12:15], s68 offen lds
    s_add_u32 s68, s66, 46080
    s_add_u32 m0, s67, 5760
    s_nop 0
    buffer_load_dwordx4 v5, s[12:15], s68 offen lds
    s_add_u32 s68, s66, 53760
    s_add_u32 m0, s67, 6720
    s_nop 0
    buffer_load_dwordx4 v5, s[12:15], s68 offen lds
    s_mov_b32 exec_hi, -1
    s_add_u32 s65, s65, 128
    s_add_u32 s66, s66, 245760
    s_cmp_eq_u32 s65, 1280
    s_cselect_b32 s65, 0, s65
    s_cselect_b32 s66, 0, s66
    s_add_u32 s61, s61, 47104
    s_cmp_eq_u32 s61, 141312
    s_cselect_b32 s61, 0, s61
    s_cmp_lg_u32 s36, 0
    s_cbranch_scc1 st_none_3
    s_cmp_eq_u32 s70, 5
    s_cbranch_scc1 st_pub_4
    s_cmp_lg_u32 s70, 3
    s_cbranch_scc1 st_none_3
    buffer_load_dword v17, v10, s[28:31], 0 offen sc1
    s_branch st_none_3
st_pub_4:
    ds_read_b32 v16, v11
    ds_read_b32 v18, v11 offset:4
    v_readfirstlane_b32 s50, v17
    s_nop 0
    s_cmp_lg_u32 s50, 0
    s_cbranch_scc1 st_have_5
    s_mov_b32 exec_lo, 0xffffffff
    s_mov_b32 exec_hi, 0xffffffff
    s_mov_b32 s59, 0
poll_6:
    buffer_load_dword v17, v10, s[28:31], 0 offen sc1
    s_waitcnt vmcnt(0)
    v_cmp_eq_u32 vcc, 0, v17
    s_nop 4
    s_cbranch_vccz poll_done_7
    s_sleep 8
    s_add_u32 s59, s59, 1
    s_cmp_lt_u32 s59, 0x10000
    s_cbranch_scc1 poll_6
poll_done_7:
    s_mov_b64 exec, -1
st_have_5:
    v_mov_b32 v19, v17
    s_lshl_b32 s50, s81, 7
    s_add_u32 s50, s50, 0xb2b000
    s_waitcnt lgkmcnt(0)
    s_mov_b64 exec, 0xff
    buffer_store_dwordx4 v[16:19], v12, s[24:27], s50 offen sc1
    s_mov_b64 exec, -1
st_none_3:
    s_add_u32 s70, s70, 1
    s_cmp_lt_u32 s70, 6
    s_cbranch_scc1 ldA_loop_1
    s_mul_i32 s41, s72, 241
    s_lshr_b32 s41, s41, 12
    s_mul_i32 s42, s41, 17
    s_sub_u32 s42, s72, s42
    s_lshl_b32 s43, s42, 2
    s_add_u32 s43, s43, s36
    s_cmp_ge_u32 s43, 20
    s_cselect_b32 s76, s84, s22
    s_cselect_b32 s77, s85, s23
    s_and_b32 s77, s77, 0xffff
    s_cmp_ge_u32 s43, 20
    s_mov_b32 s50, 0xc8000
    s_cselect_b32 s78, 0x1e0000, s50
    s_mov_b32 s79, 0x20000
    s_cselect_b32 s50, 20, 0
    s_sub_u32 s50, s43, s50
    s_mul_i32 s50, s50, 40960
    s_mul_i32 s51, s41, 160
    s_add_u32 s45, s50, s51
    s_mul_i32 s46, s41, 68
    s_add_u32 s46, s46, s43
    s_mul_i32 s46, s46, 5120
    s_add_u32 s46, s46, 0x880000
    s_lshl_b32 s47, s41, 9
    s_lshl_b32 s51, s43, 2
    s_add_u32 s47, s47, s51
    s_add_u32 s47, s47, 0xb2a000
    s_cmp_ge_u32 s72, 136
    s_cselect_b32 s45, 0x7f000000, s45
    s_cselect_b32 s46, 0x7f000000, s46
    s_cselect_b32 s47, 0x7f000000, s47
    s_mul_i32 s44, s36, 5120
    s_add_u32 s44, s44, 143360
    v_add_u32 v6, 0, v0
    v_mul_u32_u24 v7, 0xcd, v6
    v_lshrrev_b32 v7, 11, v7
    v_mul_u32_u24 v8, 10, v7
    v_sub_u32 v8, v6, v8
    v_mul_u32_u24 v7, 0x500, v7
    v_lshl_add_u32 v10, v8, 4, v7
    v_add_u32 v6, 64, v0
    v_mul_u32_u24 v7, 0xcd, v6
    v_lshrrev_b32 v7, 11, v7
    v_mul_u32_u24 v8, 10, v7
    v_sub_u32 v8, v6, v8
    v_mul_u32_u24 v7, 0x500, v7
    v_lshl_add_u32 v11, v8, 4, v7
    v_add_u32 v6, 128, v0
    v_mul_u32_u24 v7, 0xcd, v6
    v_lshrrev_b32 v7, 11, v7
    v_mul_u32_u24 v8, 10, v7
    v_sub_u32 v8, v6, v8
    v_mul_u32_u24 v7, 0x500, v7
    v_lshl_add_u32 v12, v8, 4, v7
    v_add_u32 v6, 192, v0
    v_mul_u32_u24 v7, 0xcd, v6
    v_lshrrev_b32 v7, 11, v7
    v_mul_u32_u24 v8, 10, v7
    v_sub_u32 v8, v6, v8
    v_mul_u32_u24 v7, 0x500, v7
    v_lshl_add_u32 v13, v8, 4, v7
    v_add_u32 v6, 256, v0
    v_mul_u32_u24 v7, 0xcd, v6
    v_lshrrev_b32 v7, 11, v7
    v_mul_u32_u24 v8, 10, v7
    v_sub_u32 v8, v6, v8
    v_mul_u32_u24 v7, 0x500, v7
    v_lshl_add_u32 v14, v8, 4, v7
    v_lshrrev_b32 v15, 2, v0
    v_mul_u32_u24 v15, 160, v15
    v_and_b32 v6, 3, v0
    v_lshl_add_u32 v15, v6, 3, v15
    v_add_u32 v15, s44, v15
    v_lshlrev_b32 v244, 4, v0
    v_min_u32 v41, 31, v0
    s_mul_i32 s50, s36, 32
    v_add_u32 v41, s50, v41
    s_mul_i32 s50, s33, 112
    s_sub_u32 s50, s50, 16
    v_add_u32 v40, s50, v41
    v_max_i32 v40, 0, v40
    v_min_i32 v40, 0x7ff, v40
    v_lshlrev_b32 v40, 4, v40
    v_add_u32 v40, 0xb2b000, v40
    v_lshlrev_b32 v41, 2, v41
    v_add_u32 v41, 0xe400, v41
    v_mov_b32 v6, 0
    s_waitcnt vmcnt(12)
    s_barrier
    s_add_u32 s67, s61, s63
    s_add_u32 m0, s67, 0
    s_mov_b32 exec_lo, s71
    buffer_load_dwordx4 v1, s[8:11], s65 offen lds
    s_mov_b32 exec_lo, -1
    s_add_u32 m0, s67, 4096
    s_nop 0
    buffer_load_dwordx4 v2, s[8:11], s65 offen lds
    s_add_u32 m0, s67, 8192
    s_nop 0
    buffer_load_dwordx4 v3, s[8:11], s65 offen lds
    s_add_u32 m0, s67, 12288
    s_nop 0
    buffer_load_dwordx4 v4, s[8:11], s65 offen lds
    s_add_u32 s67, s61, s64
    s_mov_b32 exec_hi, 0x0fffffff
    s_add_u32 s68, s66, 0
    s_add_u32 m0, s67, 0
    s_nop 0
    buffer_load_dwordx4 v5, s[12:15], s68 offen lds
    s_add_u32 s68, s66, 7680
    s_add_u32 m0, s67, 960
    s_nop 0
    buffer_load_dwordx4 v5, s[12:15], s68 offen lds
    s_add_u32 s68, s66, 30720
    s_add_u32 m0, s67, 1920
    s_nop 0
    buffer_load_dwordx4 v5, s[12:15], s68 offen lds
    s_add_u32 s68, s66, 38400
    s_add_u32 m0, s67, 2880
    s_nop 0
    buffer_load_dwordx4 v5, s[12:15], s68 offen lds
    s_add_u32 s68, s66, 15360
    s_add_u32 m0, s67, 3840
    s_nop 0
    buffer_load_dwordx4 v5, s[12:15], s68 offen lds
    s_add_u32 s68, s66, 23040
    s_add_u32 m0, s67, 4800
    s_nop 0
    buffer_load_dwordx4 v5, s[12:15], s68 offen lds
    s_add_u32 s68, s66, 46080
    s_add_u32 m0, s67, 5760
    s_nop 0
    buffer_load_dwordx4 v5, s[12:15], s68 offen lds
    s_add_u32 s68, s66, 53760
    s_add_u32 m0, s67, 6720
    s_nop 0
    buffer_load_dwordx4 v5, s[12:15], s68 offen lds
    s_mov_b32 exec_hi, -1
    s_add_u32 s65, s65, 128
    s_add_u32 s66, s66, 245760
    s_cmp_eq_u32 s65, 1280
    s_cselect_b32 s65, 0, s65
    s_cselect_b32 s66, 0, s66
    s_add_u32 s61, s61, 47104
    s_cmp_eq_u32 s61, 141312
    s_cselect_b32 s61, 0, s61
    s_add_u32 m0, s44, 0
    s_nop 0
    buffer_load_dwordx4 v10, s[76:79], s45 offen lds
    s_add_u32 m0, s44, 1024
    s_nop 0
    buffer_load_dwordx4 v11, s[76:79], s45 offen lds
    s_add_u32 m0, s44, 2048
    s_nop 0
    buffer_load_dwordx4 v12, s[76:79], s45 offen lds
    s_add_u32 m0, s44, 3072
    s_nop 0
    buffer_load_dwordx4 v13, s[76:79], s45 offen lds
    s_add_u32 m0, s44, 4096
    s_nop 0
    buffer_load_dwordx4 v14, s[76:79], s45 offen lds
    buffer_load_dword v9, v6, s[28:31], 0 offen sc1
    s_waitcnt vmcnt(18)
    s_barrier
    s_add_u32 s67, s61, s63
    s_add_u32 m0, s67, 0
    s_mov_b32 exec_lo, s71
    buffer_load_dwordx4 v1, s[8:11], s65 offen lds
    s_mov_b32 exec_lo, -1
    s_add_u32 m0, s67, 4096
    s_nop 0
    buffer_load_dwordx4 v2, s[8:11], s65 offen lds
    s_add_u32 m0, s67, 8192
    s_nop 0
    buffer_load_dwordx4 v3, s[8:11], s65 offen lds
    s_add_u32 m0, s67, 12288
    s_nop 0
    buffer_load_dwordx4 v4, s[8:11], s65 offen lds
    s_add_u32 s67, s61, s64
    s_mov_b32 exec_hi, 0x0fffffff
    s_add_u32 s68, s66, 0
    s_add_u32 m0, s67, 0
    s_nop 0
    buffer_load_dwordx4 v5, s[12:15], s68 offen lds
    s_add_u32 s68, s66, 7680
    s_add_u32 m0, s67, 960
    s_nop 0
    buffer_load_dwordx4 v5, s[12:15], s68 offen lds
    s_add_u32 s68, s66, 30720
    s_add_u32 m0, s67, 1920
    s_nop 0
    buffer_load_dwordx4 v5, s[12:15], s68 offen lds
    s_add_u32 s68, s66, 38400
    s_add_u32 m0, s67, 2880
    s_nop 0
    buffer_load_dwordx4 v5, s[12:15], s68 offen lds
    s_add_u32 s68, s66, 15360
    s_add_u32 m0, s67, 3840
    s_nop 0
    buffer_load_dwordx4 v5, s[12:15], s68 offen lds
    s_add_u32 s68, s66, 23040
    s_add_u32 m0, s67, 4800
    s_nop 0
    buffer_load_dwordx4 v5, s[12:15], s68 offen lds
    s_add_u32 s68, s66, 46080
    s_add_u32 m0, s67, 5760
    s_nop 0
    buffer_load_dwordx4 v5, s[12:15], s68 offen lds
    s_add_u32 s68, s66, 53760
    s_add_u32 m0, s67, 6720
    s_nop 0
    buffer_load_dwordx4 v5, s[12:15], s68 offen lds
    s_mov_b32 exec_hi, -1
    s_add_u32 s65, s65, 128
    s_add_u32 s66, s66, 245760
    s_cmp_eq_u32 s65, 1280
    s_cselect_b32 s65, 0, s65
    s_cselect_b32 s66, 0, s66
    s_add_u32 s61, s61, 47104
    s_cmp_eq_u32 s61, 141312
    s_cselect_b32 s61, 0, s61
    s_waitcnt vmcnt(18)
    s_barrier
    s_add_u32 s67, s61, s63
    s_add_u32 m0, s67, 0
    s_mov_b32 exec_lo, s71
    buffer_load_dwordx4 v1, s[8:11], s65 offen lds
    s_mov_b32 exec_lo, -1
    s_add_u32 m0, s67, 4096
    s_nop 0
    buffer_load_dwordx4 v2, s[8:11], s65 offen lds
    s_add_u32 m0, s67, 8192
    s_nop 0
    buffer_load_dwordx4 v3, s[8:11], s65 offen lds
    s_add_u32 m0, s67, 12288
    s_nop 0
    buffer_load_dwordx4 v4, s[8:11], s65 offen lds
    s_add_u32 s67, s61, s64
    s_mov_b32 exec_hi, 0x0fffffff
    s_add_u32 s68, s66, 0
    s_add_u32 m0, s67, 0
    s_nop 0
    buffer_load_dwordx4 v5, s[12:15], s68 offen lds
    s_add_u32 s68, s66, 7680
    s_add_u32 m0, s67, 960
    s_nop 0
    buffer_load_dwordx4 v5, s[12:15], s68 offen lds
    s_add_u32 s68, s66, 30720
    s_add_u32 m0, s67, 1920
    s_nop 0
    buffer_load_dwordx4 v5, s[12:15], s68 offen lds
    s_add_u32 s68, s66, 38400
    s_add_u32 m0, s67, 2880
    s_nop 0
    buffer_load_dwordx4 v5, s[12:15], s68 offen lds
    s_add_u32 s68, s66, 15360
    s_add_u32 m0, s67, 3840
    s_nop 0
    buffer_load_dwordx4 v5, s[12:15], s68 offen lds
    s_add_u32 s68, s66, 23040
    s_add_u32 m0, s67, 4800
    s_nop 0
    buffer_load_dwordx4 v5, s[12:15], s68 offen lds
    s_add_u32 s68, s66, 46080
    s_add_u32 m0, s67, 5760
    s_nop 0
    buffer_load_dwordx4 v5, s[12:15], s68 offen lds
    s_add_u32 s68, s66, 53760
    s_add_u32 m0, s67, 6720
    s_nop 0
    buffer_load_dwordx4 v5, s[12:15], s68 offen lds
    s_mov_b32 exec_hi, -1
    s_add_u32 s65, s65, 128
    s_add_u32 s66, s66, 245760
    s_cmp_eq_u32 s65, 1280
    s_cselect_b32 s65, 0, s65
    s_cselect_b32 s66, 0, s66
    s_add_u32 s61, s61, 47104
    s_cmp_eq_u32 s61, 141312
    s_cselect_b32 s61, 0, s61
    s_waitcnt vmcnt(12)
    s_barrier
    s_add_u32 s67, s61, s63
    s_add_u32 m0, s67, 0
    s_mov_b32 exec_lo, s71
    buffer_load_dwordx4 v1, s[8:11], s65 offen lds
    s_mov_b32 exec_lo, -1
    s_add_u32 m0, s67, 4096
    s_nop 0
    buffer_load_dwordx4 v2, s[8:11], s65 offen lds
    s_add_u32 m0, s67, 8192
    s_nop 0
    buffer_load_dwordx4 v3, s[8:11], s65 offen lds
    s_add_u32 m0, s67, 12288
    s_nop 0
    buffer_load_dwordx4 v4, s[8:11], s65 offen lds
    s_add_u32 s67, s61, s64
    s_mov_b32 exec_hi, 0x0fffffff
    s_add_u32 s68, s66, 0
    s_add_u32 m0, s67, 0
    s_nop 0
    buffer_load_dwordx4 v5, s[12:15], s68 offen lds
    s_add_u32 s68, s66, 7680
    s_add_u32 m0, s67, 960
    s_nop 0
    buffer_load_dwordx4 v5, s[12:15], s68 offen lds
    s_add_u32 s68, s66, 30720
    s_add_u32 m0, s67, 1920
    s_nop 0
    buffer_load_dwordx4 v5, s[12:15], s68 offen lds
    s_add_u32 s68, s66, 38400
    s_add_u32 m0, s67, 2880
    s_nop 0
    buffer_load_dwordx4 v5, s[12:15], s68 offen lds
    s_add_u32 s68, s66, 15360
    s_add_u32 m0, s67, 3840
    s_nop 0
    buffer_load_dwordx4 v5, s[12:15], s68 offen lds
    s_add_u32 s68, s66, 23040
    s_add_u32 m0, s67, 4800
    s_nop 0
    buffer_load_dwordx4 v5, s[12:15], s68 offen lds
    s_add_u32 s68, s66, 46080
    s_add_u32 m0, s67, 5760
    s_nop 0
    buffer_load_dwordx4 v5, s[12:15], s68 offen lds
    s_add_u32 s68, s66, 53760
    s_add_u32 m0, s67, 6720
    s_nop 0
    buffer_load_dwordx4 v5, s[12:15], s68 offen lds
    s_mov_b32 exec_hi, -1
    s_add_u32 s65, s65, 128
    s_add_u32 s66, s66, 245760
    s_cmp_eq_u32 s65, 1280
    s_cselect_b32 s65, 0, s65
    s_cselect_b32 s66, 0, s66
    s_add_u32 s61, s61, 47104
    s_cmp_eq_u32 s61, 141312
    s_cselect_b32 s61, 0, s61
    v_readfirstlane_b32 s73, v9
    s_nop 0
    s_cmp_lg_u32 s73, 0
    s_cbranch_scc1 havenonce_8
    s_mov_b32 exec_lo, 0x1
    s_mov_b32 exec_hi, 0x0
    s_mov_b32 s59, 0
poll_9:
    buffer_load_dword v9, v6, s[28:31], 0 offen sc1
    s_waitcnt vmcnt(0)
    v_cmp_eq_u32 vcc, 0, v9
    s_nop 4
    s_cbranch_vccz poll_done_10
    s_sleep 8
    s_add_u32 s59, s59, 1
    s_cmp_lt_u32 s59, 0x10000
    s_cbranch_scc1 poll_9
poll_done_10:
    s_mov_b64 exec, -1
    v_readfirstlane_b32 s73, v9
havenonce_8:
    s_cmp_ge_u32 s72, 136
    s_cbranch_scc1 rl_skip_11
    ds_read_b64_tr_b16 v[16:17], v15 offset:0
    ds_read_b64_tr_b16 v[18:19], v15 offset:2560
    ds_read_b64_tr_b16 v[20:21], v15 offset:32
    ds_read_b64_tr_b16 v[22:23], v15 offset:2592
    ds_read_b64_tr_b16 v[24:25], v15 offset:64
    ds_read_b64_tr_b16 v[26:27], v15 offset:2624
    ds_read_b64_tr_b16 v[28:29], v15 offset:96
    ds_read_b64_tr_b16 v[30:31], v15 offset:2656
    ds_read_b64_tr_b16 v[32:33], v15 offset:128
    ds_read_b64_tr_b16 v[34:35], v15 offset:2688
    s_add_u32 s51, s46, 4096
    s_waitcnt lgkmcnt(8)
    buffer_store_dwordx4 v[16:19], v244, s[24:27], s46 offen offset:0 sc1
    s_waitcnt lgkmcnt(6)
    buffer_store_dwordx4 v[20:23], v244, s[24:27], s46 offen offset:1024 sc1
    s_waitcnt lgkmcnt(4)
    buffer_store_dwordx4 v[24:27], v244, s[24:27], s46 offen offset:2048 sc1
    s_waitcnt lgkmcnt(2)
    buffer_store_dwordx4 v[28:31], v244, s[24:27], s46 offen offset:3072 sc1
    s_waitcnt lgkmcnt(0)
    buffer_store_dwordx4 v[32:35], v244, s[24:27], s51 offen sc1
rl_skip_11:
    s_waitcnt vmcnt(12)
    s_barrier
    buffer_load_dwordx4 v[36:39], v40, s[24:27], 0 offen sc1
    v_lshlrev_b32 v244, 4, v0
    s_mul_i32 s62, s82, 278528
    s_lshl_b32 s63, s36, 12
    s_add_u32 s62, s62, s63
    s_mul_i32 s64, s36, 5120
    s_mul_i32 s69, s83, 348160
    s_add_u32 s69, s69, s64
    s_add_u32 s69, s69, 0x880000
    s_add_u32 s64, s64, 61440
    s_mov_b32 s61, 0
    s_mov_b32 s66, 0
    s_add_u32 s62, s62, 81920
    s_add_u32 s69, s69, 102400
    s_lshl_b32 s50, s83, 9
    s_add_u32 s50, s50, 0xb2a000
    v_lshlrev_b32 v245, 3, v0
    v_add_u32 v245, s50, v245
    s_lshl_b32 s54, s82, 7
    s_add_u32 s54, s54, 0xb28000
    v_and_b32 v246, 31, v0
    v_lshlrev_b32 v246, 2, v246
    v_add_u32 v246, s54, v246
    s_lshl_b32 s51, s82, 2
    s_add_u32 s55, s51, 3
    s_mul_i32 s52, s51, 103
    s_lshr_b32 s52, s52, 9
    s_mul_i32 s53, s55, 103
    s_lshr_b32 s53, s53, 9
    s_lshl_b32 s52, s52, 6
    s_lshl_b32 s53, s53, 6
    s_add_u32 s52, s52, 0xb29000
    s_add_u32 s53, s53, 0xb28fc0
    v_mov_b32 v243, s52
    v_mov_b32 v247, s53
    v_cmp_lt_u32 s[52:53], 15, v0
    s_nop 1
    v_cndmask_b32 v243, v243, v247, s[52:53]
    v_lshl_add_u32 v243, v0, 2, v243
    s_waitcnt vmcnt(1)
    s_barrier
    v_mov_b32 v7, s47
    v_mov_b32 v8, s73
    s_waitcnt vmcnt(1)
    s_mov_b64 exec, 1
    buffer_store_dword v8, v7, s[24:27], 0 offen sc1
    s_mov_b64 exec, -1
    s_waitcnt vmcnt(1)
    s_mov_b32 s59, 0
st_chk_12:
    v_cmp_ne_u32 vcc, s73, v37
    v_cmp_ne_u32 s[50:51], s73, v39
    s_nop 4
    s_or_b64 s[50:51], s[50:51], vcc
    s_cbranch_scc0 st_ok_13
    s_sleep 8
    buffer_load_dwordx4 v[36:39], v40, s[24:27], 0 offen sc1
    s_waitcnt vmcnt(0)
    s_add_u32 s59, s59, 1
    s_cmp_lt_u32 s59, 0x10000
    s_cbranch_scc1 st_chk_12
st_ok_13:
    s_barrier
    ds_write_b32 v41, v36
    ds_write_b32 v41, v38 offset:640
    v_mov_b32 v7, 0xecc0
    v_mov_b32 v8, s73
    ds_write_b32 v7, v8
    s_waitcnt lgkmcnt(0)
    s_setprio 1
    v_lshrrev_b32 v124, 4, v0
    v_and_b32 v125, 15, v0
    s_mov_b32 s42, 0xffff0000
    s_mov_b32 s43, -1
    s_mov_b32 s44, 0
    s_mov_b32 s45, -1
    s_mov_b32 s46, 0
    s_mov_b32 s47, 0xffff0000
    v_mov_b32 v129, 0xff800000
    v_mov_b32 v126, 0
    v_lshlrev_b32 v130, 2, v124
    v_sub_u32 v130, v125, v130
    v_add_u32 v132, 16, v130
    v_and_b32 v132, 0xfffffff1, v132
    v_cmp_eq_u32 s[54:55], 0, v132
    s_nop 1
    v_cndmask_b32 v132, v129, v126, s[54:55]
    v_add_u32 v133, 15, v130
    v_and_b32 v133, 0xfffffff1, v133
    v_cmp_eq_u32 s[56:57], 0, v133
    s_nop 1
    v_cndmask_b32 v133, v129, v126, s[56:57]
    v_add_u32 v134, 14, v130
    v_and_b32 v134, 0xfffffff1, v134
    v_cmp_eq_u32 s[54:55], 0, v134
    s_nop 1
    v_cndmask_b32 v134, v129, v126, s[54:55]
    v_add_u32 v135, 13, v130
    v_and_b32 v135, 0xfffffff1, v135
    v_cmp_eq_u32 s[56:57], 0, v135
    s_nop 1
    v_cndmask_b32 v135, v129, v126, s[56:57]
    v_add_u32 v136, 0, v130
    v_and_b32 v136, 0xfffffff1, v136
    v_cmp_eq_u32 s[54:55], 0, v136
    s_nop 1
    v_cndmask_b32 v136, v129, v126, s[54:55]
    v_add_u32 v137, -1, v130
    v_and_b32 v137, 0xfffffff1, v137
    v_cmp_eq_u32 s[56:57], 0, v137
    s_nop 1
    v_cndmask_b32 v137, v129, v126, s[56:57]
    v_add_u32 v138, -2, v130
    v_and_b32 v138, 0xfffffff1, v138
    v_cmp_eq_u32 s[54:55], 0, v138
    s_nop 1
    v_cndmask_b32 v138, v129, v126, s[54:55]
    v_add_u32 v139, -3, v130
    v_and_b32 v139, 0xfffffff1, v139
    v_cmp_eq_u32 s[56:57], 0, v139
    s_nop 1
    v_cndmask_b32 v139, v129, v126, s[56:57]
    v_mov_b32 v76, 0x3f803f80
    v_mov_b32 v77, 0x3f803f80
    v_mov_b32 v78, 0x3f803f80
    v_mov_b32 v79, 0x3f803f80
    s_mul_i32 s50, s36, 14592
    v_add_u32 v127, s50, v244
    s_sub_u32 s50, s50, 14592
    v_add_u32 v128, s50, v244
    s_barrier
    s_barrier
    s_cmp_lg_u32 s36, 0
    s_cbranch_scc1 helper_14
    s_barrier
    s_branch p2_loaderA
helper_14:
    ds_read_b128 v[140:143], v128 offset:2048
    ds_read_b128 v[152:155], v127 offset:0
    ds_read_b128 v[144:147], v128 offset:3072
    ds_read_b128 v[156:159], v127 offset:1024
    ds_read_b64 v[148:149], v128 offset:4104
    ds_read_b64 v[160:161], v127 offset:4096
    ds_read_b128 v[164:167], v127 offset:10240
    ds_read_b128 v[168:171], v127 offset:11264
    ds_read_b128 v[172:175], v127 offset:12288
    ds_read_b128 v[176:179], v127 offset:13312
    v_lshlrev_b32 v129, 2, v0
    s_mul_i32 s50, s36, 14592
    v_add_u32 v129, s50, v129
    ds_read_b32 v200, v129 offset:14336
    s_waitcnt lgkmcnt(4)
    ds_read_b64 v[180:181], v128 offset:5128
    ds_read_b64 v[182:183], v127 offset:5120
    ds_read_b64 v[184:185], v128 offset:6152
    ds_read_b64 v[186:187], v127 offset:6144
    ds_read_b64 v[188:189], v128 offset:7176
    ds_read_b64 v[190:191], v127 offset:7168
    ds_read_b64 v[192:193], v128 offset:8200
    ds_read_b64 v[194:195], v127 offset:8192
    ds_read_b64 v[196:197], v128 offset:9224
    ds_read_b64 v[198:199], v127 offset:9216
    s_waitcnt lgkmcnt(0)
    s_barrier
    v_mfma_f32_16x16x32_bf16 v[4:7], v[140:143], v[164:167], 0
    v_mfma_f32_16x16x32_bf16 v[8:11], v[152:155], v[164:167], 0
    v_mfma_f32_16x16x32_bf16 v[12:15], v[142:145], v[168:171], 0
    v_mfma_f32_16x16x32_bf16 v[16:19], v[154:157], v[168:171], 0
    v_mfma_f32_16x16x32_bf16 v[20:23], v[144:147], v[172:175], 0
    v_mfma_f32_16x16x32_bf16 v[24:27], v[156:159], v[172:175], 0
    v_mfma_f32_16x16x32_bf16 v[28:31], v[146:149], v[176:179], 0
    v_mfma_f32_16x16x32_bf16 v[32:35], v[158:161], v[176:179], 0
    s_mul_i32 s54, s33, 7
    s_lshl_b32 s55, s36, 1
    s_add_u32 s54, s54, s55
    s_sub_u32 s54, s54, 1
    s_lshr_b32 s55, s54, 2
    s_mul_i32 s55, s55, 278528
    s_and_b32 s56, s54, 3
    s_lshl_b32 s56, s56, 10
    s_add_u32 s58, s56, s55
    s_mul_i32 s55, s34, 5
    v_pk_fma_f32 v[4:5], v[4:5], v[200:201], v[132:133] op_sel_hi:[1,0,1]
    v_pk_fma_f32 v[6:7], v[6:7], v[200:201], v[134:135] op_sel_hi:[1,0,1]
    v_pk_fma_f32 v[8:9], v[8:9], v[200:201], v[136:137] op_sel_hi:[1,0,1]
    v_pk_fma_f32 v[10:11], v[10:11], v[200:201], v[138:139] op_sel_hi:[1,0,1]
    v_pk_fma_f32 v[12:13], v[12:13], v[200:201], v[132:133] op_sel_hi:[1,0,1]
    v_pk_fma_f32 v[14:15], v[14:15], v[200:201], v[134:135] op_sel_hi:[1,0,1]
    v_pk_fma_f32 v[16:17], v[16:17], v[200:201], v[136:137] op_sel_hi:[1,0,1]
    v_pk_fma_f32 v[18:19], v[18:19], v[200:201], v[138:139] op_sel_hi:[1,0,1]
    v_pk_fma_f32 v[20:21], v[20:21], v[200:201], v[132:133] op_sel_hi:[1,0,1]
    v_pk_fma_f32 v[22:23], v[22:23], v[200:201], v[134:135] op_sel_hi:[1,0,1]
    v_pk_fma_f32 v[24:25], v[24:25], v[200:201], v[136:137] op_sel_hi:[1,0,1]
    v_pk_fma_f32 v[26:27], v[26:27], v[200:201], v[138:139] op_sel_hi:[1,0,1]
    v_pk_fma_f32 v[28:29], v[28:29], v[200:201], v[132:133] op_sel_hi:[1,0,1]
    v_pk_fma_f32 v[30:31], v[30:31], v[200:201], v[134:135] op_sel_hi:[1,0,1]
    v_pk_fma_f32 v[32:33], v[32:33], v[200:201], v[136:137] op_sel_hi:[1,0,1]
    v_pk_fma_f32 v[34:35], v[34:35], v[200:201], v[138:139] op_sel_hi:[1,0,1]
    v_max3_f32 v52, v4, v5, v6
    v_max3_f32 v53, v7, v8, v9
    v_max3_f32 v52, v52, v10, v11
    v_max_f32 v52, v52, v53
    v_mov_b32 v53, v52
    v_max3_f32 v54, v12, v13, v14
    v_max3_f32 v55, v15, v16, v17
    v_max3_f32 v54, v54, v18, v19
    v_max_f32 v54, v54, v55
    v_mov_b32 v55, v54
    v_max3_f32 v56, v20, v21, v22
    v_max3_f32 v57, v23, v24, v25
    v_max3_f32 v56, v56, v26, v27
    v_max_f32 v56, v56, v57
    v_mov_b32 v57, v56
    v_max3_f32 v58, v28, v29, v30
    v_max3_f32 v59, v31, v32, v33
    v_max3_f32 v58, v58, v34, v35
    v_max_f32 v58, v58, v59
    v_mov_b32 v59, v58
    v_permlane32_swap_b32 v52, v53
    v_permlane32_swap_b32 v54, v55
    v_permlane32_swap_b32 v56, v57
    v_permlane32_swap_b32 v58, v59
    v_max_f32 v52, v52, v53
    v_mov_b32 v53, v52
    v_max_f32 v54, v54, v55
    v_mov_b32 v55, v54
    v_max_f32 v56, v56, v57
    v_mov_b32 v57, v56
    v_max_f32 v58, v58, v59
    v_mov_b32 v59, v58
    v_permlane16_swap_b32 v52, v53
    v_permlane16_swap_b32 v54, v55
    v_permlane16_swap_b32 v56, v57
    v_permlane16_swap_b32 v58, v59
    v_max_f32 v52, v52, v53
    v_max_f32 v54, v54, v55
    v_max_f32 v56, v56, v57
    v_max_f32 v58, v58, v59
    v_pk_add_f32 v[4:5], v[4:5], v[52:53] op_sel_hi:[1,0] neg_lo:[0,1] neg_hi:[0,1]
    v_pk_add_f32 v[6:7], v[6:7], v[52:53] op_sel_hi:[1,0] neg_lo:[0,1] neg_hi:[0,1]
    v_pk_add_f32 v[8:9], v[8:9], v[52:53] op_sel_hi:[1,0] neg_lo:[0,1] neg_hi:[0,1]
    v_pk_add_f32 v[10:11], v[10:11], v[52:53] op_sel_hi:[1,0] neg_lo:[0,1] neg_hi:[0,1]
    v_exp_f32 v4, v4
    v_exp_f32 v5, v5
    v_exp_f32 v6, v6
    v_exp_f32 v7, v7
    v_exp_f32 v8, v8
    v_exp_f32 v9, v9
    v_exp_f32 v10, v10
    v_exp_f32 v11, v11
    v_pk_add_f32 v[12:13], v[12:13], v[54:55] op_sel_hi:[1,0] neg_lo:[0,1] neg_hi:[0,1]
    v_pk_add_f32 v[14:15], v[14:15], v[54:55] op_sel_hi:[1,0] neg_lo:[0,1] neg_hi:[0,1]
    v_pk_add_f32 v[16:17], v[16:17], v[54:55] op_sel_hi:[1,0] neg_lo:[0,1] neg_hi:[0,1]
    v_pk_add_f32 v[18:19], v[18:19], v[54:55] op_sel_hi:[1,0] neg_lo:[0,1] neg_hi:[0,1]
    v_exp_f32 v12, v12
    v_exp_f32 v13, v13
    v_exp_f32 v14, v14
    v_exp_f32 v15, v15
    v_exp_f32 v16, v16
    v_exp_f32 v17, v17
    v_exp_f32 v18, v18
    v_exp_f32 v19, v19
    v_cvt_pk_bf16_f32 v36, v4, v5
    v_cvt_pk_bf16_f32 v37, v6, v7
    v_cvt_pk_bf16_f32 v38, v8, v9
    v_cvt_pk_bf16_f32 v39, v10, v11
    s_nop 1
    v_mfma_f32_16x16x32_bf16 v[60:63], v[76:79], v[36:39], 0
    v_mfma_f32_16x16x32_bf16 v[4:7], v[180:183], v[36:39], 0
    v_mfma_f32_16x16x32_bf16 v[8:11], v[184:187], v[36:39], 0
    v_pk_add_f32 v[20:21], v[20:21], v[56:57] op_sel_hi:[1,0] neg_lo:[0,1] neg_hi:[0,1]
    v_pk_add_f32 v[22:23], v[22:23], v[56:57] op_sel_hi:[1,0] neg_lo:[0,1] neg_hi:[0,1]
    v_pk_add_f32 v[24:25], v[24:25], v[56:57] op_sel_hi:[1,0] neg_lo:[0,1] neg_hi:[0,1]
    v_pk_add_f32 v[26:27], v[26:27], v[56:57] op_sel_hi:[1,0] neg_lo:[0,1] neg_hi:[0,1]
    v_exp_f32 v20, v20
    v_exp_f32 v21, v21
    v_exp_f32 v22, v22
    v_exp_f32 v23, v23
    v_exp_f32 v24, v24
    v_exp_f32 v25, v25
    v_exp_f32 v26, v26
    v_exp_f32 v27, v27
    v_cvt_pk_bf16_f32 v40, v12, v13
    v_cvt_pk_bf16_f32 v41, v14, v15
    v_cvt_pk_bf16_f32 v42, v16, v17
    v_cvt_pk_bf16_f32 v43, v18, v19
    s_nop 1
    v_mfma_f32_16x16x32_bf16 v[64:67], v[76:79], v[40:43], 0
    v_mfma_f32_16x16x32_bf16 v[12:15], v[184:187], v[40:43], 0
    v_mfma_f32_16x16x32_bf16 v[16:19], v[188:191], v[40:43], 0
    v_pk_add_f32 v[28:29], v[28:29], v[58:59] op_sel_hi:[1,0] neg_lo:[0,1] neg_hi:[0,1]
    v_pk_add_f32 v[30:31], v[30:31], v[58:59] op_sel_hi:[1,0] neg_lo:[0,1] neg_hi:[0,1]
    v_pk_add_f32 v[32:33], v[32:33], v[58:59] op_sel_hi:[1,0] neg_lo:[0,1] neg_hi:[0,1]
    v_pk_add_f32 v[34:35], v[34:35], v[58:59] op_sel_hi:[1,0] neg_lo:[0,1] neg_hi:[0,1]
    v_exp_f32 v28, v28
    v_exp_f32 v29, v29
    v_exp_f32 v30, v30
    v_exp_f32 v31, v31
    v_exp_f32 v32, v32
    v_exp_f32 v33, v33
    v_exp_f32 v34, v34
    v_exp_f32 v35, v35
    v_cvt_pk_bf16_f32 v44, v20, v21
    v_cvt_pk_bf16_f32 v45, v22, v23
    v_cvt_pk_bf16_f32 v46, v24, v25
    v_cvt_pk_bf16_f32 v47, v26, v27
    s_nop 1
    v_mfma_f32_16x16x32_bf16 v[68:71], v[76:79], v[44:47], 0
    v_mfma_f32_16x16x32_bf16 v[20:23], v[188:191], v[44:47], 0
    v_mfma_f32_16x16x32_bf16 v[24:27], v[192:195], v[44:47], 0
    v_cvt_pk_bf16_f32 v48, v28, v29
    v_cvt_pk_bf16_f32 v49, v30, v31
    v_cvt_pk_bf16_f32 v50, v32, v33
    v_cvt_pk_bf16_f32 v51, v34, v35
    s_nop 1
    v_mfma_f32_16x16x32_bf16 v[72:75], v[76:79], v[48:51], 0
    v_mfma_f32_16x16x32_bf16 v[28:31], v[192:195], v[48:51], 0
    v_mfma_f32_16x16x32_bf16 v[32:35], v[196:199], v[48:51], 0
    v_rcp_f32 v60, v60
    s_nop 0
    v_pk_mul_f32 v[4:5], v[4:5], v[60:61] op_sel_hi:[1,0]
    v_pk_mul_f32 v[6:7], v[6:7], v[60:61] op_sel_hi:[1,0]
    v_cvt_pk_bf16_f32 v204, v4, v5
    v_cvt_pk_bf16_f32 v205, v6, v7
    v_rcp_f32 v64, v64
    v_cndmask_b32 v12, v8, v12, s[42:43]
    v_cndmask_b32 v13, v9, v13, s[42:43]
    v_cndmask_b32 v14, v10, v14, s[42:43]
    v_cndmask_b32 v15, v11, v15, s[42:43]
    v_cndmask_b32 v80, v60, v64, s[42:43]
    v_pk_mul_f32 v[12:13], v[12:13], v[80:81] op_sel_hi:[1,0]
    v_pk_mul_f32 v[14:15], v[14:15], v[80:81] op_sel_hi:[1,0]
    v_cvt_pk_bf16_f32 v206, v12, v13
    v_cvt_pk_bf16_f32 v207, v14, v15
    v_rcp_f32 v68, v68
    v_cndmask_b32 v20, v16, v20, s[44:45]
    v_cndmask_b32 v21, v17, v21, s[44:45]
    v_cndmask_b32 v22, v18, v22, s[44:45]
    v_cndmask_b32 v23, v19, v23, s[44:45]
    v_cndmask_b32 v80, v64, v68, s[44:45]
    v_pk_mul_f32 v[20:21], v[20:21], v[80:81] op_sel_hi:[1,0]
    v_pk_mul_f32 v[22:23], v[22:23], v[80:81] op_sel_hi:[1,0]
    v_cvt_pk_bf16_f32 v208, v20, v21
    v_cvt_pk_bf16_f32 v209, v22, v23
    v_rcp_f32 v72, v72
    v_cndmask_b32 v28, v24, v28, s[46:47]
    v_cndmask_b32 v29, v25, v29, s[46:47]
    v_cndmask_b32 v30, v26, v30, s[46:47]
    v_cndmask_b32 v31, v27, v31, s[46:47]
    v_cndmask_b32 v80, v68, v72, s[46:47]
    v_pk_mul_f32 v[28:29], v[28:29], v[80:81] op_sel_hi:[1,0]
    v_pk_mul_f32 v[30:31], v[30:31], v[80:81] op_sel_hi:[1,0]
    v_cvt_pk_bf16_f32 v210, v28, v29
    v_cvt_pk_bf16_f32 v211, v30, v31
    v_pk_mul_f32 v[32:33], v[32:33], v[72:73] op_sel_hi:[1,0]
    v_pk_mul_f32 v[34:35], v[34:35], v[72:73] op_sel_hi:[1,0]
    v_cvt_pk_bf16_f32 v212, v32, v33
    v_cvt_pk_bf16_f32 v213, v34, v35
    v_and_b32 v52, 16, v0
    v_lshlrev_b32 v52, 5, v52
    v_and_b32 v53, 32, v0
    v_lshl_add_u32 v52, v53, 3, v52
    v_and_b32 v53, 15, v0
    v_lshl_add_u32 v52, v53, 4, v52
    s_cmp_ge_u32 s54, 128
    s_cbranch_scc1 att_nost_15
    s_lshr_b32 s57, s55, 1
    s_lshl_b32 s57, s57, 12
    s_add_u32 s58, s58, s57
    s_add_u32 s59, s58, 4096
    s_add_u32 s60, s58, 8192
    s_bitcmp1_b32 s34, 0
    s_cbranch_scc1 att_odd_16
    v_permlane16_swap_b32 v204, v206
    v_permlane16_swap_b32 v205, v207
    v_permlane16_swap_b32 v208, v210
    v_permlane16_swap_b32 v209, v211
    v_permlane16_swap_b32 v212, v214
    v_permlane16_swap_b32 v213, v215
    buffer_store_dwordx4 v[204:207], v52, s[24:27], s58 offen sc1
    buffer_store_dwordx4 v[208:211], v52, s[24:27], s59 offen sc1
    s_mov_b32 exec_lo, 0xffff
    s_mov_b32 exec_hi, 0xffff
    buffer_store_dwordx4 v[212:215], v52, s[24:27], s60 offen sc1
    s_mov_b64 exec, -1
    s_branch att_fl_17
att_odd_16:
    v_permlane16_swap_b32 v202, v204
    v_permlane16_swap_b32 v203, v205
    v_permlane16_swap_b32 v206, v208
    v_permlane16_swap_b32 v207, v209
    v_permlane16_swap_b32 v210, v212
    v_permlane16_swap_b32 v211, v213
    s_mov_b32 exec_lo, 0xffff0000
    s_mov_b32 exec_hi, 0xffff0000
    buffer_store_dwordx4 v[202:205], v52, s[24:27], s58 offen sc1
    s_mov_b64 exec, -1
    buffer_store_dwordx4 v[206:209], v52, s[24:27], s59 offen sc1
    buffer_store_dwordx4 v[210:213], v52, s[24:27], s60 offen sc1
att_fl_17:
    s_lshl_b32 s54, s54, 5
    s_lshl_b32 s55, s34, 2
    s_add_u32 s54, s54, s55
    s_add_u32 s54, s54, 0xb28000
    v_mov_b32 v80, s54
    v_mov_b32 v81, s73
    s_waitcnt vmcnt(0)
    s_mov_b64 exec, 1
    buffer_store_dword v81, v80, s[24:27], 0 offen sc1
    s_mov_b64 exec, -1
att_nost_15:
    s_branch p2_loaderA
k_typeB:
    s_sub_u32 s47, s41, s45
    s_lshr_b32 s47, s47, 1
    s_mul_i32 s33, s37, 6
    s_add_u32 s33, s33, s47
    s_cmp_lt_u32 s32, 4
    s_cbranch_scc1 k_cB
    s_mul_i32 s48, s33, 160
    s_add_u32 s48, s48, 80
    s_mul_i32 s48, s48, 586
    s_lshr_b32 s35, s48, 16
    s_cmp_ge_u32 s35, 10
    s_cselect_b32 s48, 10, 0
    s_sub_u32 s35, s35, s48
    s_mov_b32 s48, 0x76543210
    s_mov_b32 s49, 0x98
    s_lshl_b32 s35, s35, 2
    s_lshr_b64 s[48:49], s[48:49], s35
    s_and_b32 s35, s48, 15
    s_mul_i32 s46, s44, 3
    s_add_u32 s35, s35, s46
    s_add_u32 s35, s35, 9
    s_cmp_ge_u32 s35, 10
    s_cselect_b32 s48, 10, 0
    s_sub_u32 s35, s35, s48
    s_cmp_ge_u32 s35, 10
    s_cselect_b32 s48, 10, 0
    s_sub_u32 s35, s35, s48
    s_setprio 3
    v_lshrrev_b32 v9, 3, v0
    s_lshl_b32 s50, s36, 3
    v_add_u32 v9, s50, v9
    v_lshrrev_b32 v10, 1, v9
    v_xor_b32 v10, v10, v0
    v_and_b32 v10, 7, v10
    v_lshlrev_b32 v10, 4, v10
    s_mul_i32 s50, s33, 160
    v_add_u32 v9, s50, v9
    s_movk_i32 s51, 0x500
    s_movk_i32 s52, 0x7ff
    v_add_u32 v11, 0, v9
    v_max_i32 v11, 0, v11
    v_min_i32 v11, s52, v11
    v_mad_u32_u24 v1, v11, s51, v10
    v_add_u32 v11, 32, v9
    v_max_i32 v11, 0, v11
    v_min_i32 v11, s52, v11
    v_mad_u32_u24 v2, v11, s51, v10
    v_add_u32 v11, 64, v9
    v_max_i32 v11, 0, v11
    v_min_i32 v11, s52, v11
    v_mad_u32_u24 v3, v11, s51, v10
    v_add_u32 v11, 96, v9
    v_max_i32 v11, 0, v11
    v_min_i32 v11, s52, v11
    v_mad_u32_u24 v4, v11, s51, v10
    v_add_u32 v11, 128, v9
    v_max_i32 v11, 0, v11
    v_min_i32 v11, s52, v11
    v_mad_u32_u24 v5, v11, s51, v10
    s_mul_i32 s50, s34, 384
    s_mul_i32 s51, s36, 49152
    s_add_u32 s50, s50, s51
    v_add_u32 v9, 0, v0
    v_mul_u32_u24 v10, 0xab, v9
    v_lshrrev_b32 v10, 12, v10
    v_mul_u32_u24 v11, 24, v10
    v_sub_u32 v11, v9, v11
    v_and_b32 v12, 6, v10
    v_xor_b32 v11, v11, v12
    v_lshlrev_b32 v11, 4, v11
    v_lshrrev_b32 v12, 2, v10
    v_lshlrev_b32 v12, 3, v12
    v_and_b32 v10, 3, v10
    v_add_u32 v10, v10, v12
    v_mul_u32_u24 v10, 0xc00, v10
    v_add3_u32 v6, v10, v11, s50
    v_add_u32 v9, 64, v0
    v_mul_u32_u24 v10, 0xab, v9
    v_lshrrev_b32 v10, 12, v10
    v_mul_u32_u24 v11, 24, v10
    v_sub_u32 v11, v9, v11
    v_and_b32 v12, 6, v10
    v_xor_b32 v11, v11, v12
    v_lshlrev_b32 v11, 4, v11
    v_lshrrev_b32 v12, 2, v10
    v_lshlrev_b32 v12, 3, v12
    v_and_b32 v10, 3, v10
    v_add_u32 v10, v10, v12
    v_mul_u32_u24 v10, 0xc00, v10
    v_add3_u32 v7, v10, v11, s50
    v_add_u32 v9, 128, v0
    v_mul_u32_u24 v10, 0xab, v9
    v_lshrrev_b32 v10, 12, v10
    v_mul_u32_u24 v11, 24, v10
    v_sub_u32 v11, v9, v11
    v_and_b32 v12, 6, v10
    v_xor_b32 v11, v11, v12
    v_lshlrev_b32 v11, 4, v11
    v_lshrrev_b32 v12, 2, v10
    v_lshlrev_b32 v12, 3, v12
    v_and_b32 v10, 3, v10
    v_add_u32 v10, v10, v12
    v_mul_u32_u24 v10, 0xc00, v10
    v_add3_u32 v8, v10, v11, s50
    s_lshl_b32 s65, s35, 7
    s_mul_i32 s66, s35, 196608
    s_mov_b32 s61, 0
    s_lshl_b32 s63, s36, 10
    s_mul_i32 s64, s36, 6144
    s_add_u32 s64, s64, 20480
    s_waitcnt lgkmcnt(0)
    s_mov_b32 s8, s4
    s_and_b32 s9, s5, 0xffff
    s_mov_b32 s10, 0x280000
    s_mov_b32 s11, 0x20000
    s_mov_b32 s24, s20
    s_and_b32 s25, s21, 0xffff
    s_mov_b32 s26, 0xb33000
    s_mov_b32 s27, 0x20000
    s_mov_b32 s12, s16
    s_and_b32 s13, s17, 0xffff
    s_mov_b32 s14, 0x1e0000
    s_mov_b32 s15, 0x20000
    s_mov_b32 s28, s90
    s_and_b32 s29, s91, 0xffff
    s_mov_b32 s30, 0x100
    s_mov_b32 s31, 0x20000
    v_mov_b32 v13, 0
    v_and_b32 v14, 7, v0
    v_lshlrev_b32 v14, 3, v14
    v_add_u32 v14, 0x22c00, v14
    v_lshlrev_b32 v15, 4, v0
    v_mov_b32 v21, 0
    s_mov_b32 s70, 0
ldB_loop_18:
    s_cmp_lt_u32 s70, 2
    s_cbranch_scc1 ldB_in_19
    s_waitcnt vmcnt(11)
    s_barrier
ldB_in_19:
    s_add_u32 s67, s61, s63
    s_add_u32 m0, s67, 0
    s_nop 0
    buffer_load_dwordx4 v1, s[8:11], s65 offen lds
    s_add_u32 m0, s67, 4096
    s_nop 0
    buffer_load_dwordx4 v2, s[8:11], s65 offen lds
    s_add_u32 m0, s67, 8192
    s_nop 0
    buffer_load_dwordx4 v3, s[8:11], s65 offen lds
    s_add_u32 m0, s67, 12288
    s_nop 0
    buffer_load_dwordx4 v4, s[8:11], s65 offen lds
    s_add_u32 m0, s67, 16384
    s_nop 0
    buffer_load_dwordx4 v5, s[8:11], s65 offen lds
    s_add_u32 s67, s61, s64
    s_add_u32 s68, s66, 0
    s_add_u32 m0, s67, 0
    s_nop 0
    buffer_load_dwordx4 v6, s[12:15], s68 offen lds
    s_add_u32 m0, s67, 1024
    s_nop 0
    buffer_load_dwordx4 v7, s[12:15], s68 offen lds
    s_add_u32 m0, s67, 2048
    s_nop 0
    buffer_load_dwordx4 v8, s[12:15], s68 offen lds
    s_add_u32 s68, s66, 12288
    s_add_u32 m0, s67, 3072
    s_nop 0
    buffer_load_dwordx4 v6, s[12:15], s68 offen lds
    s_add_u32 m0, s67, 4096
    s_nop 0
    buffer_load_dwordx4 v7, s[12:15], s68 offen lds
    s_add_u32 m0, s67, 5120
    s_nop 0
    buffer_load_dwordx4 v8, s[12:15], s68 offen lds
    s_add_u32 s65, s65, 128
    s_add_u32 s66, s66, 196608
    s_cmp_eq_u32 s65, 1280
    s_cselect_b32 s65, 0, s65
    s_cselect_b32 s66, 0, s66
    s_add_u32 s61, s61, 45056
    s_cmp_eq_u32 s61, 135168
    s_cselect_b32 s61, 0, s61
    s_cmp_lg_u32 s36, 0
    s_cbranch_scc1 st_none_20
    s_cmp_eq_u32 s70, 5
    s_cbranch_scc1 st_pub_21
    s_cmp_lg_u32 s70, 3
    s_cbranch_scc1 st_none_20
    buffer_load_dword v21, v13, s[28:31], 0 offen sc1
    s_branch st_none_20
st_pub_21:
    ds_read_b32 v20, v14
    ds_read_b32 v22, v14 offset:4
    v_readfirstlane_b32 s50, v21
    s_nop 0
    s_cmp_lg_u32 s50, 0
    s_cbranch_scc1 st_have_22
    s_mov_b32 exec_lo, 0xffffffff
    s_mov_b32 exec_hi, 0xffffffff
    s_mov_b32 s59, 0
poll_23:
    buffer_load_dword v21, v13, s[28:31], 0 offen sc1
    s_waitcnt vmcnt(0)
    v_cmp_eq_u32 vcc, 0, v21
    s_nop 4
    s_cbranch_vccz poll_done_24
    s_sleep 8
    s_add_u32 s59, s59, 1
    s_cmp_lt_u32 s59, 0x10000
    s_cbranch_scc1 poll_23
poll_done_24:
    s_mov_b64 exec, -1
st_have_22:
    v_mov_b32 v23, v21
    s_lshl_b32 s50, s81, 7
    s_add_u32 s50, s50, 0xb2b000
    s_waitcnt lgkmcnt(0)
    s_mov_b64 exec, 0xff
    buffer_store_dwordx4 v[20:23], v15, s[24:27], s50 offen sc1
    s_mov_b64 exec, -1
st_none_20:
    s_add_u32 s70, s70, 1
    s_cmp_lt_u32 s70, 6
    s_cbranch_scc1 ldB_loop_18
    s_mul_i32 s41, s72, 241
    s_lshr_b32 s41, s41, 12
    s_mul_i32 s42, s41, 17
    s_sub_u32 s42, s72, s42
    s_lshl_b32 s43, s42, 2
    s_add_u32 s43, s43, s36
    s_cmp_ge_u32 s43, 20
    s_cselect_b32 s76, s84, s22
    s_cselect_b32 s77, s85, s23
    s_and_b32 s77, s77, 0xffff
    s_cmp_ge_u32 s43, 20
    s_mov_b32 s50, 0xc8000
    s_cselect_b32 s78, 0x1e0000, s50
    s_mov_b32 s79, 0x20000
    s_cselect_b32 s50, 20, 0
    s_sub_u32 s50, s43, s50
    s_mul_i32 s50, s50, 40960
    s_mul_i32 s51, s41, 160
    s_add_u32 s45, s50, s51
    s_mul_i32 s46, s41, 68
    s_add_u32 s46, s46, s43
    s_mul_i32 s46, s46, 5120
    s_add_u32 s46, s46, 0x880000
    s_lshl_b32 s47, s41, 9
    s_lshl_b32 s51, s43, 2
    s_add_u32 s47, s47, s51
    s_add_u32 s47, s47, 0xb2a000
    s_cmp_ge_u32 s72, 136
    s_cselect_b32 s45, 0x7f000000, s45
    s_cselect_b32 s46, 0x7f000000, s46
    s_cselect_b32 s47, 0x7f000000, s47
    s_mul_i32 s44, s36, 5120
    s_add_u32 s44, s44, 143360
    v_add_u32 v9, 0, v0
    v_mul_u32_u24 v10, 0xcd, v9
    v_lshrrev_b32 v10, 11, v10
    v_mul_u32_u24 v11, 10, v10
    v_sub_u32 v11, v9, v11
    v_mul_u32_u24 v10, 0x500, v10
    v_lshl_add_u32 v13, v11, 4, v10
    v_add_u32 v9, 64, v0
    v_mul_u32_u24 v10, 0xcd, v9
    v_lshrrev_b32 v10, 11, v10
    v_mul_u32_u24 v11, 10, v10
    v_sub_u32 v11, v9, v11
    v_mul_u32_u24 v10, 0x500, v10
    v_lshl_add_u32 v14, v11, 4, v10
    v_add_u32 v9, 128, v0
    v_mul_u32_u24 v10, 0xcd, v9
    v_lshrrev_b32 v10, 11, v10
    v_mul_u32_u24 v11, 10, v10
    v_sub_u32 v11, v9, v11
    v_mul_u32_u24 v10, 0x500, v10
    v_lshl_add_u32 v15, v11, 4, v10
    v_add_u32 v9, 192, v0
    v_mul_u32_u24 v10, 0xcd, v9
    v_lshrrev_b32 v10, 11, v10
    v_mul_u32_u24 v11, 10, v10
    v_sub_u32 v11, v9, v11
    v_mul_u32_u24 v10, 0x500, v10
    v_lshl_add_u32 v16, v11, 4, v10
    v_add_u32 v9, 256, v0
    v_mul_u32_u24 v10, 0xcd, v9
    v_lshrrev_b32 v10, 11, v10
    v_mul_u32_u24 v11, 10, v10
    v_sub_u32 v11, v9, v11
    v_mul_u32_u24 v10, 0x500, v10
    v_lshl_add_u32 v17, v11, 4, v10
    v_lshrrev_b32 v18, 2, v0
    v_mul_u32_u24 v18, 160, v18
    v_and_b32 v9, 3, v0
    v_lshl_add_u32 v18, v9, 3, v18
    v_add_u32 v18, s44, v18
    v_lshlrev_b32 v244, 4, v0
    v_min_u32 v45, 39, v0
    s_mul_i32 s50, s36, 40
    v_add_u32 v45, s50, v45
    s_mul_i32 s50, s33, 160
    v_add_u32 v44, s50, v45
    v_max_i32 v44, 0, v44
    v_min_i32 v44, 0x7ff, v44
    v_lshlrev_b32 v44, 4, v44
    v_add_u32 v44, 0xb2b000, v44
    v_lshlrev_b32 v45, 2, v45
    v_add_u32 v45, 0xe400, v45
    v_mov_b32 v9, 0
    s_waitcnt vmcnt(11)
    s_barrier
    s_add_u32 s67, s61, s63
    s_add_u32 m0, s67, 0
    s_nop 0
    buffer_load_dwordx4 v1, s[8:11], s65 offen lds
    s_add_u32 m0, s67, 4096
    s_nop 0
    buffer_load_dwordx4 v2, s[8:11], s65 offen lds
    s_add_u32 m0, s67, 8192
    s_nop 0
    buffer_load_dwordx4 v3, s[8:11], s65 offen lds
    s_add_u32 m0, s67, 12288
    s_nop 0
    buffer_load_dwordx4 v4, s[8:11], s65 offen lds
    s_add_u32 m0, s67, 16384
    s_nop 0
    buffer_load_dwordx4 v5, s[8:11], s65 offen lds
    s_add_u32 s67, s61, s64
    s_add_u32 s68, s66, 0
    s_add_u32 m0, s67, 0
    s_nop 0
    buffer_load_dwordx4 v6, s[12:15], s68 offen lds
    s_add_u32 m0, s67, 1024
    s_nop 0
    buffer_load_dwordx4 v7, s[12:15], s68 offen lds
    s_add_u32 m0, s67, 2048
    s_nop 0
    buffer_load_dwordx4 v8, s[12:15], s68 offen lds
    s_add_u32 s68, s66, 12288
    s_add_u32 m0, s67, 3072
    s_nop 0
    buffer_load_dwordx4 v6, s[12:15], s68 offen lds
    s_add_u32 m0, s67, 4096
    s_nop 0
    buffer_load_dwordx4 v7, s[12:15], s68 offen lds
    s_add_u32 m0, s67, 5120
    s_nop 0
    buffer_load_dwordx4 v8, s[12:15], s68 offen lds
    s_add_u32 s65, s65, 128
    s_add_u32 s66, s66, 196608
    s_cmp_eq_u32 s65, 1280
    s_cselect_b32 s65, 0, s65
    s_cselect_b32 s66, 0, s66
    s_add_u32 s61, s61, 45056
    s_cmp_eq_u32 s61, 135168
    s_cselect_b32 s61, 0, s61
    s_add_u32 m0, s44, 0
    s_nop 0
    buffer_load_dwordx4 v13, s[76:79], s45 offen lds
    s_add_u32 m0, s44, 1024
    s_nop 0
    buffer_load_dwordx4 v14, s[76:79], s45 offen lds
    s_add_u32 m0, s44, 2048
    s_nop 0
    buffer_load_dwordx4 v15, s[76:79], s45 offen lds
    s_add_u32 m0, s44, 3072
    s_nop 0
    buffer_load_dwordx4 v16, s[76:79], s45 offen lds
    s_add_u32 m0, s44, 4096
    s_nop 0
    buffer_load_dwordx4 v17, s[76:79], s45 offen lds
    buffer_load_dword v12, v9, s[28:31], 0 offen sc1
    s_mov_b32 s92, s18
    s_and_b32 s93, s19, 0xffff
    s_mov_b32 s94, 0xc00
    s_mov_b32 s95, 0x20000
    s_mul_i32 s50, s34, 384
    s_mov_b32 m0, 135168
    s_mov_b64 exec, 0xffffff
    buffer_load_dwordx4 v244, s[92:95], s50 offen lds
    s_mov_b64 exec, -1
    s_waitcnt vmcnt(18)
    s_barrier
    s_add_u32 s67, s61, s63
    s_add_u32 m0, s67, 0
    s_nop 0
    buffer_load_dwordx4 v1, s[8:11], s65 offen lds
    s_add_u32 m0, s67, 4096
    s_nop 0
    buffer_load_dwordx4 v2, s[8:11], s65 offen lds
    s_add_u32 m0, s67, 8192
    s_nop 0
    buffer_load_dwordx4 v3, s[8:11], s65 offen lds
    s_add_u32 m0, s67, 12288
    s_nop 0
    buffer_load_dwordx4 v4, s[8:11], s65 offen lds
    s_add_u32 m0, s67, 16384
    s_nop 0
    buffer_load_dwordx4 v5, s[8:11], s65 offen lds
    s_add_u32 s67, s61, s64
    s_add_u32 s68, s66, 0
    s_add_u32 m0, s67, 0
    s_nop 0
    buffer_load_dwordx4 v6, s[12:15], s68 offen lds
    s_add_u32 m0, s67, 1024
    s_nop 0
    buffer_load_dwordx4 v7, s[12:15], s68 offen lds
    s_add_u32 m0, s67, 2048
    s_nop 0
    buffer_load_dwordx4 v8, s[12:15], s68 offen lds
    s_add_u32 s68, s66, 12288
    s_add_u32 m0, s67, 3072
    s_nop 0
    buffer_load_dwordx4 v6, s[12:15], s68 offen lds
    s_add_u32 m0, s67, 4096
    s_nop 0
    buffer_load_dwordx4 v7, s[12:15], s68 offen lds
    s_add_u32 m0, s67, 5120
    s_nop 0
    buffer_load_dwordx4 v8, s[12:15], s68 offen lds
    s_add_u32 s65, s65, 128
    s_add_u32 s66, s66, 196608
    s_cmp_eq_u32 s65, 1280
    s_cselect_b32 s65, 0, s65
    s_cselect_b32 s66, 0, s66
    s_add_u32 s61, s61, 45056
    s_cmp_eq_u32 s61, 135168
    s_cselect_b32 s61, 0, s61
    s_waitcnt vmcnt(18)
    s_barrier
    s_add_u32 s67, s61, s63
    s_add_u32 m0, s67, 0
    s_nop 0
    buffer_load_dwordx4 v1, s[8:11], s65 offen lds
    s_add_u32 m0, s67, 4096
    s_nop 0
    buffer_load_dwordx4 v2, s[8:11], s65 offen lds
    s_add_u32 m0, s67, 8192
    s_nop 0
    buffer_load_dwordx4 v3, s[8:11], s65 offen lds
    s_add_u32 m0, s67, 12288
    s_nop 0
    buffer_load_dwordx4 v4, s[8:11], s65 offen lds
    s_add_u32 m0, s67, 16384
    s_nop 0
    buffer_load_dwordx4 v5, s[8:11], s65 offen lds
    s_add_u32 s67, s61, s64
    s_add_u32 s68, s66, 0
    s_add_u32 m0, s67, 0
    s_nop 0
    buffer_load_dwordx4 v6, s[12:15], s68 offen lds
    s_add_u32 m0, s67, 1024
    s_nop 0
    buffer_load_dwordx4 v7, s[12:15], s68 offen lds
    s_add_u32 m0, s67, 2048
    s_nop 0
    buffer_load_dwordx4 v8, s[12:15], s68 offen lds
    s_add_u32 s68, s66, 12288
    s_add_u32 m0, s67, 3072
    s_nop 0
    buffer_load_dwordx4 v6, s[12:15], s68 offen lds
    s_add_u32 m0, s67, 4096
    s_nop 0
    buffer_load_dwordx4 v7, s[12:15], s68 offen lds
    s_add_u32 m0, s67, 5120
    s_nop 0
    buffer_load_dwordx4 v8, s[12:15], s68 offen lds
    s_add_u32 s65, s65, 128
    s_add_u32 s66, s66, 196608
    s_cmp_eq_u32 s65, 1280
    s_cselect_b32 s65, 0, s65
    s_cselect_b32 s66, 0, s66
    s_add_u32 s61, s61, 45056
    s_cmp_eq_u32 s61, 135168
    s_cselect_b32 s61, 0, s61
    s_waitcnt vmcnt(11)
    s_barrier
    s_add_u32 s67, s61, s63
    s_add_u32 m0, s67, 0
    s_nop 0
    buffer_load_dwordx4 v1, s[8:11], s65 offen lds
    s_add_u32 m0, s67, 4096
    s_nop 0
    buffer_load_dwordx4 v2, s[8:11], s65 offen lds
    s_add_u32 m0, s67, 8192
    s_nop 0
    buffer_load_dwordx4 v3, s[8:11], s65 offen lds
    s_add_u32 m0, s67, 12288
    s_nop 0
    buffer_load_dwordx4 v4, s[8:11], s65 offen lds
    s_add_u32 m0, s67, 16384
    s_nop 0
    buffer_load_dwordx4 v5, s[8:11], s65 offen lds
    s_add_u32 s67, s61, s64
    s_add_u32 s68, s66, 0
    s_add_u32 m0, s67, 0
    s_nop 0
    buffer_load_dwordx4 v6, s[12:15], s68 offen lds
    s_add_u32 m0, s67, 1024
    s_nop 0
    buffer_load_dwordx4 v7, s[12:15], s68 offen lds
    s_add_u32 m0, s67, 2048
    s_nop 0
    buffer_load_dwordx4 v8, s[12:15], s68 offen lds
    s_add_u32 s68, s66, 12288
    s_add_u32 m0, s67, 3072
    s_nop 0
    buffer_load_dwordx4 v6, s[12:15], s68 offen lds
    s_add_u32 m0, s67, 4096
    s_nop 0
    buffer_load_dwordx4 v7, s[12:15], s68 offen lds
    s_add_u32 m0, s67, 5120
    s_nop 0
    buffer_load_dwordx4 v8, s[12:15], s68 offen lds
    s_add_u32 s65, s65, 128
    s_add_u32 s66, s66, 196608
    s_cmp_eq_u32 s65, 1280
    s_cselect_b32 s65, 0, s65
    s_cselect_b32 s66, 0, s66
    s_add_u32 s61, s61, 45056
    s_cmp_eq_u32 s61, 135168
    s_cselect_b32 s61, 0, s61
    v_readfirstlane_b32 s73, v12
    s_nop 0
    s_cmp_lg_u32 s73, 0
    s_cbranch_scc1 havenonce_25
    s_mov_b32 exec_lo, 0x1
    s_mov_b32 exec_hi, 0x0
    s_mov_b32 s59, 0
poll_26:
    buffer_load_dword v12, v9, s[28:31], 0 offen sc1
    s_waitcnt vmcnt(0)
    v_cmp_eq_u32 vcc, 0, v12
    s_nop 4
    s_cbranch_vccz poll_done_27
    s_sleep 8
    s_add_u32 s59, s59, 1
    s_cmp_lt_u32 s59, 0x10000
    s_cbranch_scc1 poll_26
poll_done_27:
    s_mov_b64 exec, -1
    v_readfirstlane_b32 s73, v12
havenonce_25:
    s_cmp_ge_u32 s72, 136
    s_cbranch_scc1 rl_skip_28
    ds_read_b64_tr_b16 v[20:21], v18 offset:0
    ds_read_b64_tr_b16 v[22:23], v18 offset:2560
    ds_read_b64_tr_b16 v[24:25], v18 offset:32
    ds_read_b64_tr_b16 v[26:27], v18 offset:2592
    ds_read_b64_tr_b16 v[28:29], v18 offset:64
    ds_read_b64_tr_b16 v[30:31], v18 offset:2624
    ds_read_b64_tr_b16 v[32:33], v18 offset:96
    ds_read_b64_tr_b16 v[34:35], v18 offset:2656
    ds_read_b64_tr_b16 v[36:37], v18 offset:128
    ds_read_b64_tr_b16 v[38:39], v18 offset:2688
    s_add_u32 s51, s46, 4096
    s_waitcnt lgkmcnt(8)
    buffer_store_dwordx4 v[20:23], v244, s[24:27], s46 offen offset:0 sc1
    s_waitcnt lgkmcnt(6)
    buffer_store_dwordx4 v[24:27], v244, s[24:27], s46 offen offset:1024 sc1
    s_waitcnt lgkmcnt(4)
    buffer_store_dwordx4 v[28:31], v244, s[24:27], s46 offen offset:2048 sc1
    s_waitcnt lgkmcnt(2)
    buffer_store_dwordx4 v[32:35], v244, s[24:27], s46 offen offset:3072 sc1
    s_waitcnt lgkmcnt(0)
    buffer_store_dwordx4 v[36:39], v244, s[24:27], s51 offen sc1
rl_skip_28:
    s_waitcnt vmcnt(11)
    s_barrier
    buffer_load_dwordx4 v[40:43], v44, s[24:27], 0 offen sc1
    v_lshlrev_b32 v244, 4, v0
    s_mul_i32 s62, s82, 278528
    s_lshl_b32 s63, s36, 12
    s_add_u32 s62, s62, s63
    s_mul_i32 s64, s36, 5120
    s_mul_i32 s69, s83, 348160
    s_add_u32 s69, s69, s64
    s_add_u32 s69, s69, 0x880000
    s_add_u32 s64, s64, 61440
    s_mov_b32 s61, 0
    s_mov_b32 s66, 0
    s_add_u32 s62, s62, 81920
    s_add_u32 s69, s69, 102400
    s_lshl_b32 s50, s83, 9
    s_add_u32 s50, s50, 0xb2a000
    v_lshlrev_b32 v245, 3, v0
    v_add_u32 v245, s50, v245
    s_lshl_b32 s54, s82, 7
    s_add_u32 s54, s54, 0xb28000
    v_and_b32 v246, 31, v0
    v_lshlrev_b32 v246, 2, v246
    v_add_u32 v246, s54, v246
    s_lshl_b32 s51, s82, 2
    s_add_u32 s55, s51, 3
    s_mul_i32 s52, s51, 103
    s_lshr_b32 s52, s52, 9
    s_mul_i32 s53, s55, 103
    s_lshr_b32 s53, s53, 9
    s_lshl_b32 s52, s52, 6
    s_lshl_b32 s53, s53, 6
    s_add_u32 s52, s52, 0xb29000
    s_add_u32 s53, s53, 0xb28fc0
    v_mov_b32 v243, s52
    v_mov_b32 v247, s53
    v_cmp_lt_u32 s[52:53], 15, v0
    s_nop 1
    v_cndmask_b32 v243, v243, v247, s[52:53]
    v_lshl_add_u32 v243, v0, 2, v243
    s_waitcnt vmcnt(1)
    s_barrier
    v_mov_b32 v10, s47
    v_mov_b32 v11, s73
    s_waitcnt vmcnt(1)
    s_mov_b64 exec, 1
    buffer_store_dword v11, v10, s[24:27], 0 offen sc1
    s_mov_b64 exec, -1
    s_waitcnt vmcnt(1)
    s_mov_b32 s59, 0
st_chk_29:
    v_cmp_ne_u32 vcc, s73, v41
    v_cmp_ne_u32 s[50:51], s73, v43
    s_nop 4
    s_or_b64 s[50:51], s[50:51], vcc
    s_cbranch_scc0 st_ok_30
    s_sleep 8
    buffer_load_dwordx4 v[40:43], v44, s[24:27], 0 offen sc1
    s_waitcnt vmcnt(0)
    s_add_u32 s59, s59, 1
    s_cmp_lt_u32 s59, 0x10000
    s_cbranch_scc1 st_chk_29
st_ok_30:
    s_barrier
    ds_write_b32 v45, v40
    ds_write_b32 v45, v42 offset:640
    v_mov_b32 v10, 0xecc0
    v_mov_b32 v11, s73
    ds_write_b32 v10, v11
    s_waitcnt lgkmcnt(0)
    s_barrier
    s_branch p2_loaderB
p2_loaderA:
    s_setprio 3
    s_cmp_lg_u32 s36, 0
    s_cbranch_scc1 p2a_skip_31
    s_mov_b32 exec_lo, 0xffffffff
    s_mov_b32 exec_hi, 0x3
    s_mov_b32 s59, 0
poll_32:
    buffer_load_dwordx2 v[248:249], v245, s[24:27], 0 offen sc1
    s_waitcnt vmcnt(0)
    v_xor_b32 v248, s73, v248
    v_xor_b32 v249, s73, v249
    v_or_b32 v248, v248, v249
    v_cmp_ne_u32 vcc, 0, v248
    s_nop 4
    s_cbranch_vccz poll_done_33
    s_sleep 8
    s_add_u32 s59, s59, 1
    s_cmp_lt_u32 s59, 0x10000
    s_cbranch_scc1 poll_32
poll_done_33:
    s_mov_b64 exec, -1
    s_mov_b32 s50, 61440
    s_mov_b32 s51, s69
bulk_34:
    s_mov_b32 m0, s50
    s_add_u32 s50, s50, 4096
    buffer_load_dwordx4 v244, s[24:27], s51 offen offset:0 sc1 lds
    buffer_load_dwordx4 v244, s[24:27], s51 offen offset:1024 sc1 lds
    buffer_load_dwordx4 v244, s[24:27], s51 offen offset:2048 sc1 lds
    buffer_load_dwordx4 v244, s[24:27], s51 offen offset:3072 sc1 lds
    s_add_u32 s51, s51, 4096
    s_waitcnt vmcnt(48)
    s_cmp_lt_u32 s50, 143360
    s_cbranch_scc1 bulk_34
    s_mov_b32 exec_lo, 0xffffffff
    s_mov_b32 exec_hi, 0x0
    s_mov_b32 s59, 0
poll_35:
    buffer_load_dword v247, v243, s[24:27], 0 offen sc1
    s_waitcnt vmcnt(0)
    v_cmp_ne_u32 vcc, s73, v247
    s_nop 4
    s_cbranch_vccz poll_done_36
    s_sleep 8
    s_add_u32 s59, s59, 1
    s_cmp_lt_u32 s59, 0x10000
    s_cbranch_scc1 poll_35
poll_done_36:
    s_mov_b64 exec, -1
    s_mov_b32 s50, 0
    s_mov_b32 s51, s62
bulk_37:
    s_mov_b32 m0, s50
    s_add_u32 s50, s50, 4096
    buffer_load_dwordx4 v244, s[24:27], s51 offen offset:0 sc1 lds
    buffer_load_dwordx4 v244, s[24:27], s51 offen offset:1024 sc1 lds
    buffer_load_dwordx4 v244, s[24:27], s51 offen offset:2048 sc1 lds
    buffer_load_dwordx4 v244, s[24:27], s51 offen offset:3072 sc1 lds
    s_add_u32 s51, s51, 4096
    s_waitcnt vmcnt(48)
    s_cmp_lt_u32 s50, 49152
    s_cbranch_scc1 bulk_37
    s_waitcnt vmcnt(0)
p2a_skip_31:
    s_add_u32 s69, s69, 81920
    s_add_u32 s62, s62, 49152
    s_branch p2_steady
p2_loaderB:
    s_barrier
    s_mov_b32 exec_lo, 0xffffffff
    s_mov_b32 exec_hi, 0x3
    s_mov_b32 s59, 0
poll_39:
    buffer_load_dwordx2 v[248:249], v245, s[24:27], 0 offen sc1
    s_waitcnt vmcnt(0)
    v_xor_b32 v248, s73, v248
    v_xor_b32 v249, s73, v249
    v_or_b32 v248, v248, v249
    v_cmp_ne_u32 vcc, 0, v248
    s_nop 4
    s_cbranch_vccz poll_done_40
    s_sleep 8
    s_add_u32 s59, s59, 1
    s_cmp_lt_u32 s59, 0x10000
    s_cbranch_scc1 poll_39
poll_done_40:
    s_mov_b64 exec, -1
    s_mov_b32 s70, 0
p2b0_41:
    s_add_u32 m0, s66, s64
    s_add_u32 s67, s69, 4096
    buffer_load_dwordx4 v244, s[24:27], s69 offen offset:0 sc1 lds
    buffer_load_dwordx4 v244, s[24:27], s69 offen offset:1024 sc1 lds
    buffer_load_dwordx4 v244, s[24:27], s69 offen offset:2048 sc1 lds
    buffer_load_dwordx4 v244, s[24:27], s69 offen offset:3072 sc1 lds
    s_add_u32 m0, m0, 4096
    s_add_u32 s66, s66, 20480
    buffer_load_dwordx4 v244, s[24:27], s67 offen sc1 lds
    s_add_u32 s69, s69, 20480
    s_cmp_eq_u32 s66, 81920
    s_cselect_b32 s66, 0, s66
    s_add_u32 s70, s70, 1
    s_cmp_lt_u32 s70, 4
    s_cbranch_scc1 p2b0_41
    s_cmp_lg_u32 s36, 1
    s_cbranch_scc1 p2_q_38
    s_mov_b32 exec_lo, 0xffffffff
    s_mov_b32 exec_hi, 0x0
    s_mov_b32 s59, 0
poll_42:
    buffer_load_dword v247, v243, s[24:27], 0 offen sc1
    s_waitcnt vmcnt(0)
    v_cmp_ne_u32 vcc, s73, v247
    s_nop 4
    s_cbranch_vccz poll_done_43
    s_sleep 8
    s_add_u32 s59, s59, 1
    s_cmp_lt_u32 s59, 0x10000
    s_cbranch_scc1 poll_42
poll_done_43:
    s_mov_b64 exec, -1
p2_q_38:
    s_waitcnt vmcnt(0)
    s_barrier
    s_add_u32 m0, s61, s63
    s_add_u32 s61, s61, 16384
    buffer_load_dwordx4 v244, s[24:27], s62 offen offset:0 sc1 lds
    buffer_load_dwordx4 v244, s[24:27], s62 offen offset:1024 sc1 lds
    buffer_load_dwordx4 v244, s[24:27], s62 offen offset:2048 sc1 lds
    buffer_load_dwordx4 v244, s[24:27], s62 offen offset:3072 sc1 lds
    s_add_u32 s62, s62, 16384
    s_cmp_eq_u32 s61, 49152
    s_cselect_b32 s61, 0, s61
    s_add_u32 m0, s61, s63
    s_add_u32 s61, s61, 16384
    buffer_load_dwordx4 v244, s[24:27], s62 offen offset:0 sc1 lds
    buffer_load_dwordx4 v244, s[24:27], s62 offen offset:1024 sc1 lds
    buffer_load_dwordx4 v244, s[24:27], s62 offen offset:2048 sc1 lds
    buffer_load_dwordx4 v244, s[24:27], s62 offen offset:3072 sc1 lds
    s_add_u32 s62, s62, 16384
    s_cmp_eq_u32 s61, 49152
    s_cselect_b32 s61, 0, s61
    s_add_u32 m0, s61, s63
    s_add_u32 s61, s61, 16384
    buffer_load_dwordx4 v244, s[24:27], s62 offen offset:0 sc1 lds
    buffer_load_dwordx4 v244, s[24:27], s62 offen offset:1024 sc1 lds
    buffer_load_dwordx4 v244, s[24:27], s62 offen offset:2048 sc1 lds
    buffer_load_dwordx4 v244, s[24:27], s62 offen offset:3072 sc1 lds
    s_add_u32 s62, s62, 16384
    s_cmp_eq_u32 s61, 49152
    s_cselect_b32 s61, 0, s61
p2_steady:
    s_waitcnt vmcnt(8)
    s_barrier
    s_waitcnt vmcnt(4)
    s_barrier
    s_add_u32 m0, s61, s63
    s_add_u32 s61, s61, 16384
    buffer_load_dwordx4 v244, s[24:27], s62 offen offset:0 sc1 lds
    buffer_load_dwordx4 v244, s[24:27], s62 offen offset:1024 sc1 lds
    buffer_load_dwordx4 v244, s[24:27], s62 offen offset:2048 sc1 lds
    buffer_load_dwordx4 v244, s[24:27], s62 offen offset:3072 sc1 lds
    s_add_u32 s62, s62, 16384
    s_cmp_eq_u32 s61, 49152
    s_cselect_b32 s61, 0, s61
    s_add_u32 m0, s66, s64
    s_add_u32 s67, s69, 4096
    buffer_load_dwordx4 v244, s[24:27], s69 offen offset:0 sc1 lds
    buffer_load_dwordx4 v244, s[24:27], s69 offen offset:1024 sc1 lds
    buffer_load_dwordx4 v244, s[24:27], s69 offen offset:2048 sc1 lds
    buffer_load_dwordx4 v244, s[24:27], s69 offen offset:3072 sc1 lds
    s_add_u32 m0, m0, 4096
    s_add_u32 s66, s66, 20480
    buffer_load_dwordx4 v244, s[24:27], s67 offen sc1 lds
    s_add_u32 s69, s69, 20480
    s_cmp_eq_u32 s66, 81920
    s_cselect_b32 s66, 0, s66
    s_waitcnt vmcnt(9)
    s_barrier
    s_add_u32 m0, s61, s63
    s_add_u32 s61, s61, 16384
    buffer_load_dwordx4 v244, s[24:27], s62 offen offset:0 sc1 lds
    buffer_load_dwordx4 v244, s[24:27], s62 offen offset:1024 sc1 lds
    buffer_load_dwordx4 v244, s[24:27], s62 offen offset:2048 sc1 lds
    buffer_load_dwordx4 v244, s[24:27], s62 offen offset:3072 sc1 lds
    s_add_u32 s62, s62, 16384
    s_cmp_eq_u32 s61, 49152
    s_cselect_b32 s61, 0, s61
    s_add_u32 m0, s66, s64
    s_add_u32 s67, s69, 4096
    buffer_load_dwordx4 v244, s[24:27], s69 offen offset:0 sc1 lds
    buffer_load_dwordx4 v244, s[24:27], s69 offen offset:1024 sc1 lds
    buffer_load_dwordx4 v244, s[24:27], s69 offen offset:2048 sc1 lds
    buffer_load_dwordx4 v244, s[24:27], s69 offen offset:3072 sc1 lds
    s_add_u32 m0, m0, 4096
    s_add_u32 s66, s66, 20480
    buffer_load_dwordx4 v244, s[24:27], s67 offen sc1 lds
    s_add_u32 s69, s69, 20480
    s_cmp_eq_u32 s66, 81920
    s_cselect_b32 s66, 0, s66
    s_waitcnt vmcnt(14)
    s_barrier
    s_add_u32 m0, s61, s63
    s_add_u32 s61, s61, 16384
    buffer_load_dwordx4 v244, s[24:27], s62 offen offset:0 sc1 lds
    buffer_load_dwordx4 v244, s[24:27], s62 offen offset:1024 sc1 lds
    buffer_load_dwordx4 v244, s[24:27], s62 offen offset:2048 sc1 lds
    buffer_load_dwordx4 v244, s[24:27], s62 offen offset:3072 sc1 lds
    s_add_u32 s62, s62, 16384
    s_cmp_eq_u32 s61, 49152
    s_cselect_b32 s61, 0, s61
    s_add_u32 m0, s66, s64
    s_add_u32 s67, s69, 4096
    buffer_load_dwordx4 v244, s[24:27], s69 offen offset:0 sc1 lds
    buffer_load_dwordx4 v244, s[24:27], s69 offen offset:1024 sc1 lds
    buffer_load_dwordx4 v244, s[24:27], s69 offen offset:2048 sc1 lds
    buffer_load_dwordx4 v244, s[24:27], s69 offen offset:3072 sc1 lds
    s_add_u32 m0, m0, 4096
    s_add_u32 s66, s66, 20480
    buffer_load_dwordx4 v244, s[24:27], s67 offen sc1 lds
    s_add_u32 s69, s69, 20480
    s_cmp_eq_u32 s66, 81920
    s_cselect_b32 s66, 0, s66
    s_waitcnt vmcnt(14)
    s_barrier
    s_add_u32 m0, s61, s63
    s_add_u32 s61, s61, 16384
    buffer_load_dwordx4 v244, s[24:27], s62 offen offset:0 sc1 lds
    buffer_load_dwordx4 v244, s[24:27], s62 offen offset:1024 sc1 lds
    buffer_load_dwordx4 v244, s[24:27], s62 offen offset:2048 sc1 lds
    buffer_load_dwordx4 v244, s[24:27], s62 offen offset:3072 sc1 lds
    s_add_u32 s62, s62, 16384
    s_cmp_eq_u32 s61, 49152
    s_cselect_b32 s61, 0, s61
    s_add_u32 m0, s66, s64
    s_add_u32 s67, s69, 4096
    buffer_load_dwordx4 v244, s[24:27], s69 offen offset:0 sc1 lds
    buffer_load_dwordx4 v244, s[24:27], s69 offen offset:1024 sc1 lds
    buffer_load_dwordx4 v244, s[24:27], s69 offen offset:2048 sc1 lds
    buffer_load_dwordx4 v244, s[24:27], s69 offen offset:3072 sc1 lds
    s_add_u32 m0, m0, 4096
    s_add_u32 s66, s66, 20480
    buffer_load_dwordx4 v244, s[24:27], s67 offen sc1 lds
    s_add_u32 s69, s69, 20480
    s_cmp_eq_u32 s66, 81920
    s_cselect_b32 s66, 0, s66
    s_waitcnt vmcnt(14)
    s_barrier
    s_add_u32 m0, s61, s63
    s_add_u32 s61, s61, 16384
    buffer_load_dwordx4 v244, s[24:27], s62 offen offset:0 sc1 lds
    buffer_load_dwordx4 v244, s[24:27], s62 offen offset:1024 sc1 lds
    buffer_load_dwordx4 v244, s[24:27], s62 offen offset:2048 sc1 lds
    buffer_load_dwordx4 v244, s[24:27], s62 offen offset:3072 sc1 lds
    s_add_u32 s62, s62, 16384
    s_cmp_eq_u32 s61, 49152
    s_cselect_b32 s61, 0, s61
    s_add_u32 m0, s66, s64
    s_add_u32 s67, s69, 4096
    buffer_load_dwordx4 v244, s[24:27], s69 offen offset:0 sc1 lds
    buffer_load_dwordx4 v244, s[24:27], s69 offen offset:1024 sc1 lds
    buffer_load_dwordx4 v244, s[24:27], s69 offen offset:2048 sc1 lds
    buffer_load_dwordx4 v244, s[24:27], s69 offen offset:3072 sc1 lds
    s_add_u32 m0, m0, 4096
    s_add_u32 s66, s66, 20480
    buffer_load_dwordx4 v244, s[24:27], s67 offen sc1 lds
    s_add_u32 s69, s69, 20480
    s_cmp_eq_u32 s66, 81920
    s_cselect_b32 s66, 0, s66
    s_waitcnt vmcnt(14)
    s_barrier
    s_add_u32 m0, s61, s63
    s_add_u32 s61, s61, 16384
    buffer_load_dwordx4 v244, s[24:27], s62 offen offset:0 sc1 lds
    buffer_load_dwordx4 v244, s[24:27], s62 offen offset:1024 sc1 lds
    buffer_load_dwordx4 v244, s[24:27], s62 offen offset:2048 sc1 lds
    buffer_load_dwordx4 v244, s[24:27], s62 offen offset:3072 sc1 lds
    s_add_u32 s62, s62, 16384
    s_cmp_eq_u32 s61, 49152
    s_cselect_b32 s61, 0, s61
    s_add_u32 m0, s66, s64
    s_add_u32 s67, s69, 4096
    buffer_load_dwordx4 v244, s[24:27], s69 offen offset:0 sc1 lds
    buffer_load_dwordx4 v244, s[24:27], s69 offen offset:1024 sc1 lds
    buffer_load_dwordx4 v244, s[24:27], s69 offen offset:2048 sc1 lds
    buffer_load_dwordx4 v244, s[24:27], s69 offen offset:3072 sc1 lds
    s_add_u32 m0, m0, 4096
    s_add_u32 s66, s66, 20480
    buffer_load_dwordx4 v244, s[24:27], s67 offen sc1 lds
    s_add_u32 s69, s69, 20480
    s_cmp_eq_u32 s66, 81920
    s_cselect_b32 s66, 0, s66
    s_waitcnt vmcnt(14)
    s_barrier
    s_add_u32 m0, s61, s63
    s_add_u32 s61, s61, 16384
    buffer_load_dwordx4 v244, s[24:27], s62 offen offset:0 sc1 lds
    buffer_load_dwordx4 v244, s[24:27], s62 offen offset:1024 sc1 lds
    buffer_load_dwordx4 v244, s[24:27], s62 offen offset:2048 sc1 lds
    buffer_load_dwordx4 v244, s[24:27], s62 offen offset:3072 sc1 lds
    s_add_u32 s62, s62, 16384
    s_cmp_eq_u32 s61, 49152
    s_cselect_b32 s61, 0, s61
    s_add_u32 m0, s66, s64
    s_add_u32 s67, s69, 4096
    buffer_load_dwordx4 v244, s[24:27], s69 offen offset:0 sc1 lds
    buffer_load_dwordx4 v244, s[24:27], s69 offen offset:1024 sc1 lds
    buffer_load_dwordx4 v244, s[24:27], s69 offen offset:2048 sc1 lds
    buffer_load_dwordx4 v244, s[24:27], s69 offen offset:3072 sc1 lds
    s_add_u32 m0, m0, 4096
    s_add_u32 s66, s66, 20480
    buffer_load_dwordx4 v244, s[24:27], s67 offen sc1 lds
    s_add_u32 s69, s69, 20480
    s_cmp_eq_u32 s66, 81920
    s_cselect_b32 s66, 0, s66
    s_waitcnt vmcnt(14)
    s_barrier
    s_add_u32 m0, s61, s63
    s_add_u32 s61, s61, 16384
    buffer_load_dwordx4 v244, s[24:27], s62 offen offset:0 sc1 lds
    buffer_load_dwordx4 v244, s[24:27], s62 offen offset:1024 sc1 lds
    buffer_load_dwordx4 v244, s[24:27], s62 offen offset:2048 sc1 lds
    buffer_load_dwordx4 v244, s[24:27], s62 offen offset:3072 sc1 lds
    s_add_u32 s62, s62, 16384
    s_cmp_eq_u32 s61, 49152
    s_cselect_b32 s61, 0, s61
    s_add_u32 m0, s66, s64
    s_add_u32 s67, s69, 4096
    buffer_load_dwordx4 v244, s[24:27], s69 offen offset:0 sc1 lds
    buffer_load_dwordx4 v244, s[24:27], s69 offen offset:1024 sc1 lds
    buffer_load_dwordx4 v244, s[24:27], s69 offen offset:2048 sc1 lds
    buffer_load_dwordx4 v244, s[24:27], s69 offen offset:3072 sc1 lds
    s_add_u32 m0, m0, 4096
    s_add_u32 s66, s66, 20480
    buffer_load_dwordx4 v244, s[24:27], s67 offen sc1 lds
    s_add_u32 s69, s69, 20480
    s_cmp_eq_u32 s66, 81920
    s_cselect_b32 s66, 0, s66
    s_sub_u32 s69, s69, 348160
    buffer_load_dword v247, v246, s[24:27], 0 offen sc1
    s_waitcnt vmcnt(15)
    s_barrier
    s_add_u32 m0, s61, s63
    s_add_u32 s61, s61, 16384
    buffer_load_dwordx4 v244, s[24:27], s62 offen offset:0 sc1 lds
    buffer_load_dwordx4 v244, s[24:27], s62 offen offset:1024 sc1 lds
    buffer_load_dwordx4 v244, s[24:27], s62 offen offset:2048 sc1 lds
    buffer_load_dwordx4 v244, s[24:27], s62 offen offset:3072 sc1 lds
    s_add_u32 s62, s62, 16384
    s_cmp_eq_u32 s61, 49152
    s_cselect_b32 s61, 0, s61
    s_sub_u32 s62, s62, 278528
    s_add_u32 m0, s66, s64
    s_add_u32 s67, s69, 4096
    buffer_load_dwordx4 v244, s[24:27], s69 offen offset:0 sc1 lds
    buffer_load_dwordx4 v244, s[24:27], s69 offen offset:1024 sc1 lds
    buffer_load_dwordx4 v244, s[24:27], s69 offen offset:2048 sc1 lds
    buffer_load_dwordx4 v244, s[24:27], s69 offen offset:3072 sc1 lds
    s_add_u32 m0, m0, 4096
    s_add_u32 s66, s66, 20480
    buffer_load_dwordx4 v244, s[24:27], s67 offen sc1 lds
    s_add_u32 s69, s69, 20480
    s_cmp_eq_u32 s66, 81920
    s_cselect_b32 s66, 0, s66
    s_waitcnt vmcnt(15)
    s_barrier
    s_waitcnt vmcnt(9)
    v_cmp_ne_u32 vcc, s73, v247
    s_nop 4
    s_cbranch_vccz p2_haveo_44
    s_mov_b32 exec_lo, 0xffffffff
    s_mov_b32 exec_hi, 0x0
    s_mov_b32 s59, 0
poll_45:
    buffer_load_dword v247, v246, s[24:27], 0 offen sc1
    s_waitcnt vmcnt(0)
    v_cmp_ne_u32 vcc, s73, v247
    s_nop 4
    s_cbranch_vccz poll_done_46
    s_sleep 8
    s_add_u32 s59, s59, 1
    s_cmp_lt_u32 s59, 0x10000
    s_cbranch_scc1 poll_45
poll_done_46:
    s_mov_b64 exec, -1
p2_haveo_44:
    s_add_u32 m0, s61, s63
    s_add_u32 s61, s61, 16384
    buffer_load_dwordx4 v244, s[24:27], s62 offen offset:0 sc1 lds
    buffer_load_dwordx4 v244, s[24:27], s62 offen offset:1024 sc1 lds
    buffer_load_dwordx4 v244, s[24:27], s62 offen offset:2048 sc1 lds
    buffer_load_dwordx4 v244, s[24:27], s62 offen offset:3072 sc1 lds
    s_add_u32 s62, s62, 16384
    s_cmp_eq_u32 s61, 49152
    s_cselect_b32 s61, 0, s61
    s_add_u32 m0, s66, s64
    s_add_u32 s67, s69, 4096
    buffer_load_dwordx4 v244, s[24:27], s69 offen offset:0 sc1 lds
    buffer_load_dwordx4 v244, s[24:27], s69 offen offset:1024 sc1 lds
    buffer_load_dwordx4 v244, s[24:27], s69 offen offset:2048 sc1 lds
    buffer_load_dwordx4 v244, s[24:27], s69 offen offset:3072 sc1 lds
    s_add_u32 m0, m0, 4096
    s_add_u32 s66, s66, 20480
    buffer_load_dwordx4 v244, s[24:27], s67 offen sc1 lds
    s_add_u32 s69, s69, 20480
    s_cmp_eq_u32 s66, 81920
    s_cselect_b32 s66, 0, s66
    s_waitcnt vmcnt(14)
    s_barrier
    s_add_u32 m0, s61, s63
    s_add_u32 s61, s61, 16384
    buffer_load_dwordx4 v244, s[24:27], s62 offen offset:0 sc1 lds
    buffer_load_dwordx4 v244, s[24:27], s62 offen offset:1024 sc1 lds
    buffer_load_dwordx4 v244, s[24:27], s62 offen offset:2048 sc1 lds
    buffer_load_dwordx4 v244, s[24:27], s62 offen offset:3072 sc1 lds
    s_add_u32 s62, s62, 16384
    s_cmp_eq_u32 s61, 49152
    s_cselect_b32 s61, 0, s61
    s_add_u32 m0, s66, s64
    s_add_u32 s67, s69, 4096
    buffer_load_dwordx4 v244, s[24:27], s69 offen offset:0 sc1 lds
    buffer_load_dwordx4 v244, s[24:27], s69 offen offset:1024 sc1 lds
    buffer_load_dwordx4 v244, s[24:27], s69 offen offset:2048 sc1 lds
    buffer_load_dwordx4 v244, s[24:27], s69 offen offset:3072 sc1 lds
    s_add_u32 m0, m0, 4096
    s_add_u32 s66, s66, 20480
    buffer_load_dwordx4 v244, s[24:27], s67 offen sc1 lds
    s_add_u32 s69, s69, 20480
    s_cmp_eq_u32 s66, 81920
    s_cselect_b32 s66, 0, s66
    s_waitcnt vmcnt(14)
    s_barrier
    s_add_u32 m0, s61, s63
    s_add_u32 s61, s61, 16384
    buffer_load_dwordx4 v244, s[24:27], s62 offen offset:0 sc1 lds
    buffer_load_dwordx4 v244, s[24:27], s62 offen offset:1024 sc1 lds
    buffer_load_dwordx4 v244, s[24:27], s62 offen offset:2048 sc1 lds
    buffer_load_dwordx4 v244, s[24:27], s62 offen offset:3072 sc1 lds
    s_add_u32 s62, s62, 16384
    s_cmp_eq_u32 s61, 49152
    s_cselect_b32 s61, 0, s61
    s_add_u32 m0, s66, s64
    s_add_u32 s67, s69, 4096
    buffer_load_dwordx4 v244, s[24:27], s69 offen offset:0 sc1 lds
    buffer_load_dwordx4 v244, s[24:27], s69 offen offset:1024 sc1 lds
    buffer_load_dwordx4 v244, s[24:27], s69 offen offset:2048 sc1 lds
    buffer_load_dwordx4 v244, s[24:27], s69 offen offset:3072 sc1 lds
    s_add_u32 m0, m0, 4096
    s_add_u32 s66, s66, 20480
    buffer_load_dwordx4 v244, s[24:27], s67 offen sc1 lds
    s_add_u32 s69, s69, 20480
    s_cmp_eq_u32 s66, 81920
    s_cselect_b32 s66, 0, s66
    s_waitcnt vmcnt(14)
    s_barrier
    s_add_u32 m0, s61, s63
    s_add_u32 s61, s61, 16384
    buffer_load_dwordx4 v244, s[24:27], s62 offen offset:0 sc1 lds
    buffer_load_dwordx4 v244, s[24:27], s62 offen offset:1024 sc1 lds
    buffer_load_dwordx4 v244, s[24:27], s62 offen offset:2048 sc1 lds
    buffer_load_dwordx4 v244, s[24:27], s62 offen offset:3072 sc1 lds
    s_add_u32 s62, s62, 16384
    s_cmp_eq_u32 s61, 49152
    s_cselect_b32 s61, 0, s61
    s_add_u32 m0, s66, s64
    s_add_u32 s67, s69, 4096
    buffer_load_dwordx4 v244, s[24:27], s69 offen offset:0 sc1 lds
    buffer_load_dwordx4 v244, s[24:27], s69 offen offset:1024 sc1 lds
    buffer_load_dwordx4 v244, s[24:27], s69 offen offset:2048 sc1 lds
    buffer_load_dwordx4 v244, s[24:27], s69 offen offset:3072 sc1 lds
    s_add_u32 m0, m0, 4096
    s_add_u32 s66, s66, 20480
    buffer_load_dwordx4 v244, s[24:27], s67 offen sc1 lds
    s_add_u32 s69, s69, 20480
    s_cmp_eq_u32 s66, 81920
    s_cselect_b32 s66, 0, s66
    s_waitcnt vmcnt(14)
    s_barrier
    s_add_u32 m0, s61, s63
    s_add_u32 s61, s61, 16384
    buffer_load_dwordx4 v244, s[24:27], s62 offen offset:0 sc1 lds
    buffer_load_dwordx4 v244, s[24:27], s62 offen offset:1024 sc1 lds
    buffer_load_dwordx4 v244, s[24:27], s62 offen offset:2048 sc1 lds
    buffer_load_dwordx4 v244, s[24:27], s62 offen offset:3072 sc1 lds
    s_add_u32 s62, s62, 16384
    s_cmp_eq_u32 s61, 49152
    s_cselect_b32 s61, 0, s61
    s_mov_b32 s28, s86
    s_and_b32 s29, s87, 0xffff
    s_mov_b32 s30, 0x500
    s_mov_b32 s31, 0x20000
    v_mul_u32_u24 v2, 0x1a, v0
    v_lshrrev_b32 v2, 8, v2
    v_mul_u32_u24 v3, 10, v2
    v_sub_u32 v3, v0, v3
    v_mul_u32_u24 v2, 0x500, v2
    v_lshl_add_u32 v2, v3, 4, v2
    s_lshl_b32 s56, s82, 6
    s_lshl_b32 s57, s36, 4
    s_add_u32 s56, s56, s57
    s_mul_i32 s56, s56, 1280
    s_mul_i32 s57, s83, 160
    s_add_u32 s56, s56, s57
    s_mul_i32 s58, s36, 3072
    s_add_u32 s58, s58, 143360
    s_mov_b32 exec_hi, 0xfffffff
    s_add_u32 m0, s58, 0
    s_add_u32 s59, s56, 0
    buffer_load_dwordx4 v2, s[8:11], s59 offen lds
    s_add_u32 m0, s58, 960
    s_add_u32 s59, s56, 7680
    buffer_load_dwordx4 v2, s[8:11], s59 offen lds
    s_mov_b32 exec_hi, 0xff
    s_add_u32 m0, s58, 1920
    s_add_u32 s59, s56, 15360
    buffer_load_dwordx4 v2, s[8:11], s59 offen lds
    s_mov_b64 exec, 0x3ff
    s_mov_b32 m0, 155648
    s_nop 0
    buffer_load_dwordx4 v244, s[28:31], s57 offen lds
    s_mov_b64 exec, -1
    s_waitcnt vmcnt(13)
    s_barrier
    s_waitcnt vmcnt(4)
    s_barrier
    s_waitcnt vmcnt(0)
    s_barrier
    s_endpgm
k_cA:
    s_waitcnt lgkmcnt(0)
    s_mov_b32 s8, s4
    s_and_b32 s9, s5, 0xffff
    s_mov_b32 s10, 0x280000
    s_mov_b32 s11, 0x20000
    s_mov_b32 s24, s20
    s_and_b32 s25, s21, 0xffff
    s_mov_b32 s26, 0xb33000
    s_mov_b32 s27, 0x20000
    v_lshrrev_b32 v215, 5, v0
    v_mul_u32_u24 v215, 0x500, v215
    v_and_b32 v216, 31, v0
    v_lshl_add_u32 v215, v216, 4, v215
    s_lshl_b32 s50, s81, 2
    s_add_u32 s50, s50, s36
    s_mul_i32 s50, s50, 2560
    v_mov_b32 v148, 0
    v_mov_b32 v149, 0
    v_mov_b32 v150, 0
    v_mov_b32 v151, 0
    buffer_load_dwordx4 v[140:143], v215, s[8:11], s50 offen
    buffer_load_dwordx4 v[144:147], v215, s[8:11], s50 offen offset:512
    s_mov_b32 exec_lo, 0xffff
    s_mov_b32 exec_hi, 0xffff
    buffer_load_dwordx4 v[148:151], v215, s[8:11], s50 offen offset:1024
    s_mov_b64 exec, -1
    s_lshl_b32 s50, s2, 2
    s_add_u32 s50, s50, s36
    s_cmp_lg_u32 s50, 3
    s_cbranch_scc1 no_nonce_47
    s_memrealtime s[50:51]
    s_mov_b32 s52, s90
    s_and_b32 s53, s91, 0xffff
    s_mov_b32 s54, 0x100
    s_mov_b32 s55, 0x20000
    v_mov_b32 v215, 0
    s_waitcnt lgkmcnt(0)
    s_or_b32 s50, s50, 1
    v_mov_b32 v216, s50
    s_mov_b64 exec, 1
    buffer_store_dword v216, v215, s[52:55], 0 offen sc1
    s_mov_b64 exec, -1
no_nonce_47:
    v_lshrrev_b32 v211, 4, v0
    v_and_b32 v212, 15, v0
    v_mov_b32 v215, 0x3f803f80
    v_lshlrev_b32 v216, 2, v0
    s_cmp_lg_u32 s36, 0
    s_cbranch_scc1 cA_noones_48
    s_mov_b32 exec_hi, 0
    ds_write_b32 v216, v215
    ds_write_b32 v216, v215 offset:47104
    v_add_u32 v216, 94208, v216
    ds_write_b32 v216, v215
    s_mov_b32 exec_hi, -1
cA_noones_48:
    v_lshrrev_b32 v215, 1, v212
    v_xor_b32 v215, v215, v211
    v_lshlrev_b32 v215, 4, v215
    v_lshl_add_u32 v215, v212, 7, v215
    s_lshl_b32 s50, s36, 12
    v_add_u32 v208, s50, v215
    v_xor_b32 v209, 64, v208
    v_lshrrev_b32 v215, 1, v211
    v_lshlrev_b32 v215, 4, v215
    v_and_b32 v216, 1, v211
    v_lshl_add_u32 v215, v216, 2, v215
    v_lshrrev_b32 v216, 2, v212
    v_add_u32 v215, v215, v216
    v_mul_u32_u24 v215, 480, v215
    v_and_b32 v216, 3, v0
    v_lshl_add_u32 v215, v216, 3, v215
    v_add_u32 v210, 16384, v215
    v_mov_b32 v4, 0
    v_mov_b32 v5, 0
    v_mov_b32 v6, 0
    v_mov_b32 v7, 0
    v_mov_b32 v8, 0
    v_mov_b32 v9, 0
    v_mov_b32 v10, 0
    v_mov_b32 v11, 0
    v_mov_b32 v12, 0
    v_mov_b32 v13, 0
    v_mov_b32 v14, 0
    v_mov_b32 v15, 0
    v_mov_b32 v16, 0
    v_mov_b32 v17, 0
    v_mov_b32 v18, 0
    v_mov_b32 v19, 0
    v_mov_b32 v20, 0
    v_mov_b32 v21, 0
    v_mov_b32 v22, 0
    v_mov_b32 v23, 0
    v_mov_b32 v24, 0
    v_mov_b32 v25, 0
    v_mov_b32 v26, 0
    v_mov_b32 v27, 0
    v_mov_b32 v28, 0
    v_mov_b32 v29, 0
    v_mov_b32 v30, 0
    v_mov_b32 v31, 0
    v_mov_b32 v32, 0
    v_mov_b32 v33, 0
    v_mov_b32 v34, 0
    v_mov_b32 v35, 0
    v_mov_b32 v36, 0
    v_mov_b32 v37, 0
    v_mov_b32 v38, 0
    v_mov_b32 v39, 0
    v_mov_b32 v40, 0
    v_mov_b32 v41, 0
    v_mov_b32 v42, 0
    v_mov_b32 v43, 0
    v_mov_b32 v44, 0
    v_mov_b32 v45, 0
    v_mov_b32 v46, 0
    v_mov_b32 v47, 0
    v_mov_b32 v48, 0
    v_mov_b32 v49, 0
    v_mov_b32 v50, 0
    v_mov_b32 v51, 0
    v_mov_b32 v52, 0
    v_mov_b32 v53, 0
    v_mov_b32 v54, 0
    v_mov_b32 v55, 0
    v_mov_b32 v56, 0
    v_mov_b32 v57, 0
    v_mov_b32 v58, 0
    v_mov_b32 v59, 0
    v_mov_b32 v60, 0
    v_mov_b32 v61, 0
    v_mov_b32 v62, 0
    v_mov_b32 v63, 0
    v_mov_b32 v64, 0
    v_mov_b32 v65, 0
    v_mov_b32 v66, 0
    v_mov_b32 v67, 0
    v_mov_b32 v68, 0
    v_mov_b32 v69, 0
    v_mov_b32 v70, 0
    v_mov_b32 v71, 0
    v_mov_b32 v72, 0
    v_mov_b32 v73, 0
    v_mov_b32 v74, 0
    v_mov_b32 v75, 0
    v_mov_b32 v76, 0
    v_mov_b32 v77, 0
    v_mov_b32 v78, 0
    v_mov_b32 v79, 0
    v_mov_b32 v80, 0
    v_mov_b32 v81, 0
    v_mov_b32 v82, 0
    v_mov_b32 v83, 0
    v_mov_b32 v84, 0
    v_mov_b32 v85, 0
    v_mov_b32 v86, 0
    v_mov_b32 v87, 0
    v_mov_b32 v88, 0
    v_mov_b32 v89, 0
    v_mov_b32 v90, 0
    v_mov_b32 v91, 0
    v_mov_b32 v92, 0
    v_mov_b32 v93, 0
    v_mov_b32 v94, 0
    v_mov_b32 v95, 0
    v_mov_b32 v96, 0
    v_mov_b32 v97, 0
    v_mov_b32 v98, 0
    v_mov_b32 v99, 0
    v_mov_b32 v100, 0
    v_mov_b32 v101, 0
    v_mov_b32 v102, 0
    v_mov_b32 v103, 0
    v_mov_b32 v104, 0
    v_mov_b32 v105, 0
    v_mov_b32 v106, 0
    v_mov_b32 v107, 0
    v_mov_b32 v108, 0
    v_mov_b32 v109, 0
    v_mov_b32 v110, 0
    v_mov_b32 v111, 0
    v_mov_b32 v112, 0
    v_mov_b32 v113, 0
    v_mov_b32 v114, 0
    v_mov_b32 v115, 0
    v_mov_b32 v116, 0
    v_mov_b32 v117, 0
    v_mov_b32 v118, 0
    v_mov_b32 v119, 0
    v_mov_b32 v120, 0
    v_mov_b32 v121, 0
    v_mov_b32 v122, 0
    v_mov_b32 v123, 0
    v_mov_b32 v196, 0x3f803f80
    v_mov_b32 v197, 0x3f803f80
    v_mov_b32 v198, 0x3f803f80
    v_mov_b32 v199, 0x3f803f80
    s_mov_b32 s42, 0xffff0000
    s_mov_b32 s43, -1
    s_mov_b32 s44, 0
    s_mov_b32 s45, -1
    s_mov_b32 s46, 0
    s_mov_b32 s47, 0xffff0000
    v_mov_b32 v215, 0xff800000
    v_mov_b32 v213, 0
    v_lshlrev_b32 v216, 2, v211
    v_sub_u32 v216, v212, v216
    v_add_u32 v200, 16, v216
    v_and_b32 v200, 0xfffffff1, v200
    v_cmp_eq_u32 s[54:55], 0, v200
    s_nop 1
    v_cndmask_b32 v200, v215, v213, s[54:55]
    v_add_u32 v201, 15, v216
    v_and_b32 v201, 0xfffffff1, v201
    v_cmp_eq_u32 s[56:57], 0, v201
    s_nop 1
    v_cndmask_b32 v201, v215, v213, s[56:57]
    v_add_u32 v202, 14, v216
    v_and_b32 v202, 0xfffffff1, v202
    v_cmp_eq_u32 s[54:55], 0, v202
    s_nop 1
    v_cndmask_b32 v202, v215, v213, s[54:55]
    v_add_u32 v203, 13, v216
    v_and_b32 v203, 0xfffffff1, v203
    v_cmp_eq_u32 s[56:57], 0, v203
    s_nop 1
    v_cndmask_b32 v203, v215, v213, s[56:57]
    v_add_u32 v204, 0, v216
    v_and_b32 v204, 0xfffffff1, v204
    v_cmp_eq_u32 s[54:55], 0, v204
    s_nop 1
    v_cndmask_b32 v204, v215, v213, s[54:55]
    v_add_u32 v205, -1, v216
    v_and_b32 v205, 0xfffffff1, v205
    v_cmp_eq_u32 s[56:57], 0, v205
    s_nop 1
    v_cndmask_b32 v205, v215, v213, s[56:57]
    v_add_u32 v206, -2, v216
    v_and_b32 v206, 0xfffffff1, v206
    v_cmp_eq_u32 s[54:55], 0, v206
    s_nop 1
    v_cndmask_b32 v206, v215, v213, s[54:55]
    v_add_u32 v207, -3, v216
    v_and_b32 v207, 0xfffffff1, v207
    v_cmp_eq_u32 s[56:57], 0, v207
    s_nop 1
    v_cndmask_b32 v207, v215, v213, s[56:57]
    s_or_b32 s50, s33, s36
    s_cmp_eq_u32 s50, 0
    s_cselect_b64 s[48:49], -1, 0
    v_cndmask_b32 v200, v200, v215, s[48:49]
    v_cndmask_b32 v201, v201, v215, s[48:49]
    v_cndmask_b32 v202, v202, v215, s[48:49]
    v_cndmask_b32 v203, v203, v215, s[48:49]
    v_mov_b32 v152, 0
    v_mov_b32 v154, 0
    s_waitcnt vmcnt(0)
    v_lshlrev_b32 v156, 16, v140
    v_and_b32 v157, 0xffff0000, v140
    v_add_f32 v152, v152, v156
    v_fmac_f32 v154, v156, v156
    v_add_f32 v152, v152, v157
    v_fmac_f32 v154, v157, v157
    v_lshlrev_b32 v156, 16, v141
    v_and_b32 v157, 0xffff0000, v141
    v_add_f32 v152, v152, v156
    v_fmac_f32 v154, v156, v156
    v_add_f32 v152, v152, v157
    v_fmac_f32 v154, v157, v157
    v_lshlrev_b32 v156, 16, v142
    v_and_b32 v157, 0xffff0000, v142
    v_add_f32 v152, v152, v156
    v_fmac_f32 v154, v156, v156
    v_add_f32 v152, v152, v157
    v_fmac_f32 v154, v157, v157
    v_lshlrev_b32 v156, 16, v143
    v_and_b32 v157, 0xffff0000, v143
    v_add_f32 v152, v152, v156
    v_fmac_f32 v154, v156, v156
    v_add_f32 v152, v152, v157
    v_fmac_f32 v154, v157, v157
    v_lshlrev_b32 v156, 16, v144
    v_and_b32 v157, 0xffff0000, v144
    v_add_f32 v152, v152, v156
    v_fmac_f32 v154, v156, v156
    v_add_f32 v152, v152, v157
    v_fmac_f32 v154, v157, v157
    v_lshlrev_b32 v156, 16, v145
    v_and_b32 v157, 0xffff0000, v145
    v_add_f32 v152, v152, v156
    v_fmac_f32 v154, v156, v156
    v_add_f32 v152, v152, v157
    v_fmac_f32 v154, v157, v157
    v_lshlrev_b32 v156, 16, v146
    v_and_b32 v157, 0xffff0000, v146
    v_add_f32 v152, v152, v156
    v_fmac_f32 v154, v156, v156
    v_add_f32 v152, v152, v157
    v_fmac_f32 v154, v157, v157
    v_lshlrev_b32 v156, 16, v147
    v_and_b32 v157, 0xffff0000, v147
    v_add_f32 v152, v152, v156
    v_fmac_f32 v154, v156, v156
    v_add_f32 v152, v152, v157
    v_fmac_f32 v154, v157, v157
    v_lshlrev_b32 v156, 16, v148
    v_and_b32 v157, 0xffff0000, v148
    v_add_f32 v152, v152, v156
    v_fmac_f32 v154, v156, v156
    v_add_f32 v152, v152, v157
    v_fmac_f32 v154, v157, v157
    v_lshlrev_b32 v156, 16, v149
    v_and_b32 v157, 0xffff0000, v149
    v_add_f32 v152, v152, v156
    v_fmac_f32 v154, v156, v156
    v_add_f32 v152, v152, v157
    v_fmac_f32 v154, v157, v157
    v_lshlrev_b32 v156, 16, v150
    v_and_b32 v157, 0xffff0000, v150
    v_add_f32 v152, v152, v156
    v_fmac_f32 v154, v156, v156
    v_add_f32 v152, v152, v157
    v_fmac_f32 v154, v157, v157
    v_lshlrev_b32 v156, 16, v151
    v_and_b32 v157, 0xffff0000, v151
    v_add_f32 v152, v152, v156
    v_fmac_f32 v154, v156, v156
    v_add_f32 v152, v152, v157
    v_fmac_f32 v154, v157, v157
    s_nop 0
    v_add_f32_dpp v152, v152, v152 quad_perm:[1,0,3,2] row_mask:0xf bank_mask:0xf
    v_add_f32_dpp v154, v154, v154 quad_perm:[1,0,3,2] row_mask:0xf bank_mask:0xf
    s_nop 0
    v_add_f32_dpp v152, v152, v152 quad_perm:[2,3,0,1] row_mask:0xf bank_mask:0xf
    v_add_f32_dpp v154, v154, v154 quad_perm:[2,3,0,1] row_mask:0xf bank_mask:0xf
    s_nop 0
    v_add_f32_dpp v152, v152, v152 row_half_mirror row_mask:0xf bank_mask:0xf
    v_add_f32_dpp v154, v154, v154 row_half_mirror row_mask:0xf bank_mask:0xf
    s_nop 0
    v_add_f32_dpp v152, v152, v152 row_mirror row_mask:0xf bank_mask:0xf
    v_add_f32_dpp v154, v154, v154 row_mirror row_mask:0xf bank_mask:0xf
    v_mov_b32 v153, v152
    v_mov_b32 v155, v154
    s_nop 0
    v_permlane16_swap_b32 v152, v153
    v_permlane16_swap_b32 v154, v155
    v_add_f32 v152, v152, v153
    v_add_f32 v154, v154, v155
    v_mul_f32 v157, 0xBACCCCCD, v152
    v_mul_f32 v156, 0x3ACCCCCD, v154
    v_fma_f32 v156, -v157, v157, v156
    v_max_f32 v156, 0, v156
    v_add_f32 v156, 0x3727c5ac, v156
    v_rsq_f32 v156, v156
    v_lshrrev_b32 v152, 5, v0
    v_lshlrev_b32 v152, 3, v152
    s_lshl_b32 s50, s36, 4
    s_add_u32 s50, s50, 142336
    v_add_u32 v152, s50, v152
    ds_write_b64 v152, v[156:157]
    v_lshlrev_b32 v214, 4, v0
    s_mov_b32 s61, 0
    s_mov_b32 s70, 0
    s_waitcnt lgkmcnt(0)
    s_barrier
    ds_read_b128 v[128:131], v208 offset:2048
    ds_read_b128 v[124:127], v208 offset:0
    ds_read_b64_tr_b16 v[140:141], v210 offset:0
    ds_read_b64_tr_b16 v[142:143], v210 offset:3840
    ds_read_b64_tr_b16 v[144:145], v210 offset:32
    ds_read_b64_tr_b16 v[146:147], v210 offset:3872
    ds_read_b64_tr_b16 v[148:149], v210 offset:64
    ds_read_b64_tr_b16 v[150:151], v210 offset:3904
    ds_read_b64_tr_b16 v[152:153], v210 offset:96
    ds_read_b64_tr_b16 v[154:155], v210 offset:3936
    ds_read_b64_tr_b16 v[156:157], v210 offset:128
    ds_read_b64_tr_b16 v[158:159], v210 offset:3968
    s_waitcnt lgkmcnt(6)
    ds_read_b64_tr_b16 v[160:161], v210 offset:160
    ds_read_b64_tr_b16 v[162:163], v210 offset:4000
    ds_read_b64_tr_b16 v[164:165], v210 offset:192
    ds_read_b64_tr_b16 v[166:167], v210 offset:4032
cA_loop_49:
    s_waitcnt lgkmcnt(8)
    v_mfma_f32_16x16x32_bf16 v[24:27], v[140:143], v[128:131], v[24:27]
    ds_read_b64_tr_b16 v[168:169], v210 offset:224
    v_mfma_f32_16x16x32_bf16 v[4:7], v[140:143], v[124:127], v[4:7]
    ds_read_b64_tr_b16 v[170:171], v210 offset:4064
    s_waitcnt lgkmcnt(8)
    v_mfma_f32_16x16x32_bf16 v[28:31], v[144:147], v[128:131], v[28:31]
    ds_read_b64_tr_b16 v[172:173], v210 offset:256
    s_add_u32 s61, s61, 1
    s_cmp_eq_u32 s61, 3
    v_mfma_f32_16x16x32_bf16 v[8:11], v[144:147], v[124:127], v[8:11]
    ds_read_b64_tr_b16 v[174:175], v210 offset:4096
    s_cselect_b32 s61, 0, s61
    s_waitcnt lgkmcnt(8)
    v_mfma_f32_16x16x32_bf16 v[32:35], v[148:151], v[128:131], v[32:35]
    ds_read_b64_tr_b16 v[176:177], v210 offset:288
    s_mov_b32 s62, 47104
    v_mfma_f32_16x16x32_bf16 v[12:15], v[148:151], v[124:127], v[12:15]
    ds_read_b64_tr_b16 v[178:179], v210 offset:4128
    s_cselect_b32 s62, 0xfffe9000, s62
    s_waitcnt lgkmcnt(8)
    v_mfma_f32_16x16x32_bf16 v[36:39], v[152:155], v[128:131], v[36:39]
    ds_read_b64_tr_b16 v[140:141], v210 offset:320
    v_add_u32 v208, s62, v208
    v_mfma_f32_16x16x32_bf16 v[16:19], v[152:155], v[124:127], v[16:19]
    ds_read_b64_tr_b16 v[142:143], v210 offset:4160
    s_waitcnt lgkmcnt(8)
    v_mfma_f32_16x16x32_bf16 v[40:43], v[156:159], v[128:131], v[40:43]
    ds_read_b64_tr_b16 v[144:145], v210 offset:352
    v_mfma_f32_16x16x32_bf16 v[20:23], v[156:159], v[124:127], v[20:23]
    ds_read_b64_tr_b16 v[146:147], v210 offset:4192
    s_waitcnt lgkmcnt(8)
    v_mfma_f32_16x16x32_bf16 v[64:67], v[160:163], v[128:131], v[64:67]
    ds_read_b64_tr_b16 v[148:149], v210 offset:384
    v_mfma_f32_16x16x32_bf16 v[44:47], v[160:163], v[124:127], v[44:47]
    ds_read_b64_tr_b16 v[150:151], v210 offset:4224
    s_waitcnt lgkmcnt(8)
    v_mfma_f32_16x16x32_bf16 v[68:71], v[164:167], v[128:131], v[68:71]
    ds_read_b64_tr_b16 v[152:153], v210 offset:416
    ds_read_b64_tr_b16 v[154:155], v210 offset:4256
    v_mfma_f32_16x16x32_bf16 v[48:51], v[164:167], v[124:127], v[48:51]
    ds_read_b128 v[136:139], v209 offset:2048
    s_waitcnt lgkmcnt(9)
    v_mfma_f32_16x16x32_bf16 v[72:75], v[168:171], v[128:131], v[72:75]
    ds_read_b64_tr_b16 v[156:157], v210 offset:448
    ds_read_b64_tr_b16 v[158:159], v210 offset:4288
    v_mfma_f32_16x16x32_bf16 v[52:55], v[168:171], v[124:127], v[52:55]
    ds_read_b128 v[132:135], v209 offset:0
    s_waitcnt lgkmcnt(10)
    v_mfma_f32_16x16x32_bf16 v[76:79], v[172:175], v[128:131], v[76:79]
    ds_read_b64_tr_b16 v[160:161], v210 offset:15360
    v_mfma_f32_16x16x32_bf16 v[56:59], v[172:175], v[124:127], v[56:59]
    ds_read_b64_tr_b16 v[162:163], v210 offset:19200
    s_waitcnt lgkmcnt(10)
    v_mfma_f32_16x16x32_bf16 v[80:83], v[176:179], v[128:131], v[80:83]
    ds_read_b64_tr_b16 v[164:165], v210 offset:15392
    v_mfma_f32_16x16x32_bf16 v[60:63], v[176:179], v[124:127], v[60:63]
    ds_read_b64_tr_b16 v[166:167], v210 offset:19232
    s_waitcnt lgkmcnt(10)
    v_mfma_f32_16x16x32_bf16 v[88:91], v[128:131], v[140:143], v[88:91]
    ds_read_b64_tr_b16 v[168:169], v210 offset:15424
    v_add_u32 v209, s62, v209
    v_mfma_f32_16x16x32_bf16 v[84:87], v[124:127], v[140:143], v[84:87]
    ds_read_b64_tr_b16 v[170:171], v210 offset:19264
    s_waitcnt lgkmcnt(10)
    v_mfma_f32_16x16x32_bf16 v[96:99], v[128:131], v[144:147], v[96:99]
    ds_read_b64_tr_b16 v[172:173], v210 offset:15456
    v_mfma_f32_16x16x32_bf16 v[92:95], v[124:127], v[144:147], v[92:95]
    ds_read_b64_tr_b16 v[174:175], v210 offset:19296
    s_waitcnt lgkmcnt(9)
    v_mfma_f32_16x16x32_bf16 v[104:107], v[128:131], v[148:151], v[104:107]
    ds_read_b64_tr_b16 v[176:177], v210 offset:15488
    v_mfma_f32_16x16x32_bf16 v[100:103], v[124:127], v[148:151], v[100:103]
    ds_read_b64_tr_b16 v[178:179], v210 offset:19328
    s_waitcnt lgkmcnt(8)
    v_mfma_f32_16x16x32_bf16 v[112:115], v[128:131], v[152:155], v[112:115]
    ds_read_b64_tr_b16 v[140:141], v210 offset:15520
    v_mfma_f32_16x16x32_bf16 v[108:111], v[124:127], v[152:155], v[108:111]
    ds_read_b64_tr_b16 v[142:143], v210 offset:19360
    s_waitcnt lgkmcnt(8)
    v_mfma_f32_16x16x32_bf16 v[120:123], v[128:131], v[156:159], v[120:123]
    ds_read_b64_tr_b16 v[144:145], v210 offset:15552
    v_mfma_f32_16x16x32_bf16 v[116:119], v[124:127], v[156:159], v[116:119]
    ds_read_b64_tr_b16 v[146:147], v210 offset:19392
    s_waitcnt lgkmcnt(8)
    v_mfma_f32_16x16x32_bf16 v[24:27], v[160:163], v[136:139], v[24:27]
    ds_read_b64_tr_b16 v[148:149], v210 offset:15584
    v_mfma_f32_16x16x32_bf16 v[4:7], v[160:163], v[132:135], v[4:7]
    ds_read_b64_tr_b16 v[150:151], v210 offset:19424
    s_waitcnt lgkmcnt(8)
    v_mfma_f32_16x16x32_bf16 v[28:31], v[164:167], v[136:139], v[28:31]
    ds_read_b64_tr_b16 v[152:153], v210 offset:15616
    v_mfma_f32_16x16x32_bf16 v[8:11], v[164:167], v[132:135], v[8:11]
    ds_read_b64_tr_b16 v[154:155], v210 offset:19456
    s_waitcnt lgkmcnt(8)
    v_mfma_f32_16x16x32_bf16 v[32:35], v[168:171], v[136:139], v[32:35]
    ds_read_b64_tr_b16 v[156:157], v210 offset:15648
    v_mfma_f32_16x16x32_bf16 v[12:15], v[168:171], v[132:135], v[12:15]
    ds_read_b64_tr_b16 v[158:159], v210 offset:19488
    s_waitcnt lgkmcnt(8)
    v_mfma_f32_16x16x32_bf16 v[36:39], v[172:175], v[136:139], v[36:39]
    ds_read_b64_tr_b16 v[160:161], v210 offset:15680
    v_mfma_f32_16x16x32_bf16 v[16:19], v[172:175], v[132:135], v[16:19]
    ds_read_b64_tr_b16 v[162:163], v210 offset:19520
    s_waitcnt lgkmcnt(8)
    v_mfma_f32_16x16x32_bf16 v[40:43], v[176:179], v[136:139], v[40:43]
    ds_read_b64_tr_b16 v[164:165], v210 offset:15712
    v_mfma_f32_16x16x32_bf16 v[20:23], v[176:179], v[132:135], v[20:23]
    ds_read_b64_tr_b16 v[166:167], v210 offset:19552
    s_waitcnt lgkmcnt(8)
    v_mfma_f32_16x16x32_bf16 v[64:67], v[140:143], v[136:139], v[64:67]
    ds_read_b64_tr_b16 v[168:169], v210 offset:15744
    v_mfma_f32_16x16x32_bf16 v[44:47], v[140:143], v[132:135], v[44:47]
    ds_read_b64_tr_b16 v[170:171], v210 offset:19584
    s_waitcnt lgkmcnt(8)
    v_mfma_f32_16x16x32_bf16 v[68:71], v[144:147], v[136:139], v[68:71]
    ds_read_b64_tr_b16 v[172:173], v210 offset:15776
    v_mfma_f32_16x16x32_bf16 v[48:51], v[144:147], v[132:135], v[48:51]
    ds_read_b64_tr_b16 v[174:175], v210 offset:19616
    s_waitcnt lgkmcnt(8)
    v_mfma_f32_16x16x32_bf16 v[72:75], v[148:151], v[136:139], v[72:75]
    ds_read_b64_tr_b16 v[176:177], v210 offset:15808
    v_mfma_f32_16x16x32_bf16 v[52:55], v[148:151], v[132:135], v[52:55]
    ds_read_b64_tr_b16 v[178:179], v210 offset:19648
    s_waitcnt lgkmcnt(8)
    v_mfma_f32_16x16x32_bf16 v[76:79], v[152:155], v[136:139], v[76:79]
    v_add_u32 v210, s62, v210
    v_mfma_f32_16x16x32_bf16 v[56:59], v[152:155], v[132:135], v[56:59]
    s_waitcnt lgkmcnt(6)
    v_mfma_f32_16x16x32_bf16 v[80:83], v[156:159], v[136:139], v[80:83]
    v_mfma_f32_16x16x32_bf16 v[60:63], v[156:159], v[132:135], v[60:63]
    s_waitcnt lgkmcnt(0)
    s_barrier
    v_mfma_f32_16x16x32_bf16 v[88:91], v[136:139], v[160:163], v[88:91]
    ds_read_b128 v[128:131], v208 offset:2048
    ds_read_b128 v[124:127], v208 offset:0
    v_mfma_f32_16x16x32_bf16 v[84:87], v[132:135], v[160:163], v[84:87]
    ds_read_b64_tr_b16 v[140:141], v210 offset:0
    ds_read_b64_tr_b16 v[142:143], v210 offset:3840
    v_mfma_f32_16x16x32_bf16 v[96:99], v[136:139], v[164:167], v[96:99]
    ds_read_b64_tr_b16 v[144:145], v210 offset:32
    ds_read_b64_tr_b16 v[146:147], v210 offset:3872
    v_mfma_f32_16x16x32_bf16 v[92:95], v[132:135], v[164:167], v[92:95]
    ds_read_b64_tr_b16 v[148:149], v210 offset:64
    ds_read_b64_tr_b16 v[150:151], v210 offset:3904
    v_mfma_f32_16x16x32_bf16 v[104:107], v[136:139], v[168:171], v[104:107]
    ds_read_b64_tr_b16 v[152:153], v210 offset:96
    ds_read_b64_tr_b16 v[154:155], v210 offset:3936
    v_mfma_f32_16x16x32_bf16 v[100:103], v[132:135], v[168:171], v[100:103]
    ds_read_b64_tr_b16 v[156:157], v210 offset:128
    ds_read_b64_tr_b16 v[158:159], v210 offset:3968
    v_mfma_f32_16x16x32_bf16 v[112:115], v[136:139], v[172:175], v[112:115]
    ds_read_b64_tr_b16 v[160:161], v210 offset:160
    v_mfma_f32_16x16x32_bf16 v[108:111], v[132:135], v[172:175], v[108:111]
    ds_read_b64_tr_b16 v[162:163], v210 offset:4000
    v_mfma_f32_16x16x32_bf16 v[120:123], v[136:139], v[176:179], v[120:123]
    ds_read_b64_tr_b16 v[164:165], v210 offset:192
    v_mfma_f32_16x16x32_bf16 v[116:119], v[132:135], v[176:179], v[116:119]
    s_waitcnt lgkmcnt(13)
    ds_read_b64_tr_b16 v[166:167], v210 offset:4032
    s_waitcnt lgkmcnt(10)
    s_add_u32 s70, s70, 1
    s_cmp_lt_u32 s70, 10
    s_cbranch_scc1 cA_loop_49
    s_waitcnt lgkmcnt(0)
    v_lshlrev_b32 v215, 4, v211
    v_add_u32 v215, 0xe900, v215
    v_lshlrev_b32 v216, 2, v212
    v_add_u32 v216, 0xeb80, v216
    s_cmp_lg_u32 s36, 0
    s_cbranch_scc1 cA_nocs_50
    s_mov_b32 exec_lo, 0x00010001
    s_mov_b32 exec_hi, 0x00010001
    ds_write_b128 v215, v[4:7] offset:0
    ds_write_b128 v215, v[44:47] offset:320
    ds_write_b128 v215, v[8:11] offset:64
    ds_write_b128 v215, v[48:51] offset:384
    ds_write_b128 v215, v[12:15] offset:128
    ds_write_b128 v215, v[52:55] offset:448
    ds_write_b128 v215, v[16:19] offset:192
    ds_write_b128 v215, v[56:59] offset:512
    ds_write_b128 v215, v[20:23] offset:256
    ds_write_b128 v215, v[60:63] offset:576
    s_mov_b64 exec, 0xffff
    ds_write_b32 v216, v84 offset:0
    ds_write_b32 v216, v92 offset:64
    ds_write_b32 v216, v100 offset:128
    ds_write_b32 v216, v108 offset:192
    ds_write_b32 v216, v116 offset:256
    s_mov_b64 exec, -1
cA_nocs_50:
    s_lshl_b32 s50, s36, 7
    v_lshlrev_b32 v217, 2, v212
    v_add_u32 v217, s50, v217
    v_add_u32 v217, 0xe400, v217
    v_lshlrev_b32 v218, 4, v211
    v_add_u32 v218, s50, v218
    v_add_u32 v218, 0xe400, v218
    s_waitcnt lgkmcnt(0)
    s_barrier
    v_mov_b32 v224, 0xecc0
    ds_read_b32 v224, v224
    ds_read_b32 v220, v217 offset:0
    ds_read_b32 v221, v217 offset:640
    ds_read_b32 v222, v217 offset:64
    ds_read_b32 v223, v217 offset:704
    ds_read_b128 v[124:127], v215 offset:320
    ds_read_b128 v[128:131], v215 offset:384
    ds_read_b128 v[132:135], v215 offset:448
    ds_read_b128 v[136:139], v215 offset:512
    ds_read_b128 v[140:143], v215 offset:576
    ds_read_b128 v[180:183], v218 offset:0
    ds_read_b128 v[188:191], v218 offset:640
    ds_read_b128 v[184:187], v218 offset:64
    ds_read_b128 v[192:195], v218 offset:704
    s_mul_i32 s50, s36, 14592
    v_add_u32 v228, s50, v214
    s_waitcnt lgkmcnt(4)
    v_readfirstlane_b32 s73, v224
    ds_read_b32 v164, v216 offset:0
    ds_read_b32 v166, v216 offset:64
    ds_read_b32 v168, v216 offset:128
    ds_read_b32 v170, v216 offset:192
    ds_read_b32 v172, v216 offset:256
    ds_read_b128 v[144:147], v215 offset:0
    ds_read_b128 v[148:151], v215 offset:64
    ds_read_b128 v[152:155], v215 offset:128
    ds_read_b128 v[156:159], v215 offset:192
    ds_read_b128 v[160:163], v215 offset:256
    v_pk_fma_f32 v[44:45], v[124:125], v[220:221], v[44:45] op_sel:[0,1,0] op_sel_hi:[1,1,1]
    v_pk_fma_f32 v[46:47], v[126:127], v[220:221], v[46:47] op_sel:[0,1,0] op_sel_hi:[1,1,1]
    v_pk_mul_f32 v[44:45], v[44:45], v[220:221] op_sel_hi:[1,0]
    v_pk_mul_f32 v[46:47], v[46:47], v[220:221] op_sel_hi:[1,0]
    v_cvt_pk_bf16_f32 v44, v44, v45
    v_cvt_pk_bf16_f32 v45, v46, v47
    v_pk_fma_f32 v[48:49], v[128:129], v[220:221], v[48:49] op_sel:[0,1,0] op_sel_hi:[1,1,1]
    v_pk_fma_f32 v[50:51], v[130:131], v[220:221], v[50:51] op_sel:[0,1,0] op_sel_hi:[1,1,1]
    v_pk_mul_f32 v[48:49], v[48:49], v[220:221] op_sel_hi:[1,0]
    v_pk_mul_f32 v[50:51], v[50:51], v[220:221] op_sel_hi:[1,0]
    v_cvt_pk_bf16_f32 v46, v48, v49
    v_cvt_pk_bf16_f32 v47, v50, v51
    v_pk_fma_f32 v[52:53], v[132:133], v[220:221], v[52:53] op_sel:[0,1,0] op_sel_hi:[1,1,1]
    v_pk_fma_f32 v[54:55], v[134:135], v[220:221], v[54:55] op_sel:[0,1,0] op_sel_hi:[1,1,1]
    v_pk_mul_f32 v[52:53], v[52:53], v[220:221] op_sel_hi:[1,0]
    v_pk_mul_f32 v[54:55], v[54:55], v[220:221] op_sel_hi:[1,0]
    v_cvt_pk_bf16_f32 v48, v52, v53
    v_cvt_pk_bf16_f32 v49, v54, v55
    v_pk_fma_f32 v[56:57], v[136:137], v[220:221], v[56:57] op_sel:[0,1,0] op_sel_hi:[1,1,1]
    v_pk_fma_f32 v[58:59], v[138:139], v[220:221], v[58:59] op_sel:[0,1,0] op_sel_hi:[1,1,1]
    v_pk_mul_f32 v[56:57], v[56:57], v[220:221] op_sel_hi:[1,0]
    v_pk_mul_f32 v[58:59], v[58:59], v[220:221] op_sel_hi:[1,0]
    v_cvt_pk_bf16_f32 v50, v56, v57
    v_cvt_pk_bf16_f32 v51, v58, v59
    v_pk_fma_f32 v[60:61], v[140:141], v[220:221], v[60:61] op_sel:[0,1,0] op_sel_hi:[1,1,1]
    v_pk_fma_f32 v[62:63], v[142:143], v[220:221], v[62:63] op_sel:[0,1,0] op_sel_hi:[1,1,1]
    v_pk_mul_f32 v[60:61], v[60:61], v[220:221] op_sel_hi:[1,0]
    v_pk_mul_f32 v[62:63], v[62:63], v[220:221] op_sel_hi:[1,0]
    v_cvt_pk_bf16_f32 v52, v60, v61
    v_cvt_pk_bf16_f32 v53, v62, v63
    s_waitcnt lgkmcnt(0)
    ds_write_b128 v228, v[44:47] offset:0
    ds_write_b128 v228, v[48:51] offset:1024
    ds_write_b64 v228, v[52:53] offset:4096
    v_pk_fma_f32 v[64:65], v[124:125], v[222:223], v[64:65] op_sel:[0,1,0] op_sel_hi:[1,1,1]
    v_pk_fma_f32 v[66:67], v[126:127], v[222:223], v[66:67] op_sel:[0,1,0] op_sel_hi:[1,1,1]
    v_pk_mul_f32 v[64:65], v[64:65], v[222:223] op_sel_hi:[1,0]
    v_pk_mul_f32 v[66:67], v[66:67], v[222:223] op_sel_hi:[1,0]
    v_cvt_pk_bf16_f32 v64, v64, v65
    v_cvt_pk_bf16_f32 v65, v66, v67
    v_pk_fma_f32 v[68:69], v[128:129], v[222:223], v[68:69] op_sel:[0,1,0] op_sel_hi:[1,1,1]
    v_pk_fma_f32 v[70:71], v[130:131], v[222:223], v[70:71] op_sel:[0,1,0] op_sel_hi:[1,1,1]
    v_pk_mul_f32 v[68:69], v[68:69], v[222:223] op_sel_hi:[1,0]
    v_pk_mul_f32 v[70:71], v[70:71], v[222:223] op_sel_hi:[1,0]
    v_cvt_pk_bf16_f32 v66, v68, v69
    v_cvt_pk_bf16_f32 v67, v70, v71
    v_pk_fma_f32 v[72:73], v[132:133], v[222:223], v[72:73] op_sel:[0,1,0] op_sel_hi:[1,1,1]
    v_pk_fma_f32 v[74:75], v[134:135], v[222:223], v[74:75] op_sel:[0,1,0] op_sel_hi:[1,1,1]
    v_pk_mul_f32 v[72:73], v[72:73], v[222:223] op_sel_hi:[1,0]
    v_pk_mul_f32 v[74:75], v[74:75], v[222:223] op_sel_hi:[1,0]
    v_cvt_pk_bf16_f32 v68, v72, v73
    v_cvt_pk_bf16_f32 v69, v74, v75
    v_pk_fma_f32 v[76:77], v[136:137], v[222:223], v[76:77] op_sel:[0,1,0] op_sel_hi:[1,1,1]
    v_pk_fma_f32 v[78:79], v[138:139], v[222:223], v[78:79] op_sel:[0,1,0] op_sel_hi:[1,1,1]
    v_pk_mul_f32 v[76:77], v[76:77], v[222:223] op_sel_hi:[1,0]
    v_pk_mul_f32 v[78:79], v[78:79], v[222:223] op_sel_hi:[1,0]
    v_cvt_pk_bf16_f32 v70, v76, v77
    v_cvt_pk_bf16_f32 v71, v78, v79
    v_pk_fma_f32 v[80:81], v[140:141], v[222:223], v[80:81] op_sel:[0,1,0] op_sel_hi:[1,1,1]
    v_pk_fma_f32 v[82:83], v[142:143], v[222:223], v[82:83] op_sel:[0,1,0] op_sel_hi:[1,1,1]
    v_pk_mul_f32 v[80:81], v[80:81], v[222:223] op_sel_hi:[1,0]
    v_pk_mul_f32 v[82:83], v[82:83], v[222:223] op_sel_hi:[1,0]
    v_cvt_pk_bf16_f32 v72, v80, v81
    v_cvt_pk_bf16_f32 v73, v82, v83
    ds_write_b128 v228, v[64:67] offset:2048
    ds_write_b128 v228, v[68:71] offset:3072
    ds_write_b64 v228, v[72:73] offset:4104
    v_pk_fma_f32 v[84:85], v[188:189], v[164:165], v[84:85] op_sel_hi:[1,0,1]
    v_pk_fma_f32 v[86:87], v[190:191], v[164:165], v[86:87] op_sel_hi:[1,0,1]
    v_pk_mul_f32 v[84:85], v[84:85], v[180:181]
    v_pk_mul_f32 v[86:87], v[86:87], v[182:183]
    v_cvt_pk_bf16_f32 v87, v86, v87
    v_cvt_pk_bf16_f32 v86, v84, v85
    v_pk_fma_f32 v[88:89], v[192:193], v[164:165], v[88:89] op_sel_hi:[1,0,1]
    v_pk_fma_f32 v[90:91], v[194:195], v[164:165], v[90:91] op_sel_hi:[1,0,1]
    v_pk_mul_f32 v[88:89], v[88:89], v[184:185]
    v_pk_mul_f32 v[90:91], v[90:91], v[186:187]
    v_cvt_pk_bf16_f32 v88, v88, v89
    v_cvt_pk_bf16_f32 v89, v90, v91
    ds_write_b128 v228, v[86:89] offset:5120
    v_pk_fma_f32 v[92:93], v[188:189], v[166:167], v[92:93] op_sel_hi:[1,0,1]
    v_pk_fma_f32 v[94:95], v[190:191], v[166:167], v[94:95] op_sel_hi:[1,0,1]
    v_pk_mul_f32 v[92:93], v[92:93], v[180:181]
    v_pk_mul_f32 v[94:95], v[94:95], v[182:183]
    v_cvt_pk_bf16_f32 v95, v94, v95
    v_cvt_pk_bf16_f32 v94, v92, v93
    v_pk_fma_f32 v[96:97], v[192:193], v[166:167], v[96:97] op_sel_hi:[1,0,1]
    v_pk_fma_f32 v[98:99], v[194:195], v[166:167], v[98:99] op_sel_hi:[1,0,1]
    v_pk_mul_f32 v[96:97], v[96:97], v[184:185]
    v_pk_mul_f32 v[98:99], v[98:99], v[186:187]
    v_cvt_pk_bf16_f32 v96, v96, v97
    v_cvt_pk_bf16_f32 v97, v98, v99
    ds_write_b128 v228, v[94:97] offset:6144
    v_pk_fma_f32 v[100:101], v[188:189], v[168:169], v[100:101] op_sel_hi:[1,0,1]
    v_pk_fma_f32 v[102:103], v[190:191], v[168:169], v[102:103] op_sel_hi:[1,0,1]
    v_pk_mul_f32 v[100:101], v[100:101], v[180:181]
    v_pk_mul_f32 v[102:103], v[102:103], v[182:183]
    v_cvt_pk_bf16_f32 v103, v102, v103
    v_cvt_pk_bf16_f32 v102, v100, v101
    v_pk_fma_f32 v[104:105], v[192:193], v[168:169], v[104:105] op_sel_hi:[1,0,1]
    v_pk_fma_f32 v[106:107], v[194:195], v[168:169], v[106:107] op_sel_hi:[1,0,1]
    v_pk_mul_f32 v[104:105], v[104:105], v[184:185]
    v_pk_mul_f32 v[106:107], v[106:107], v[186:187]
    v_cvt_pk_bf16_f32 v104, v104, v105
    v_cvt_pk_bf16_f32 v105, v106, v107
    ds_write_b128 v228, v[102:105] offset:7168
    v_pk_fma_f32 v[108:109], v[188:189], v[170:171], v[108:109] op_sel_hi:[1,0,1]
    v_pk_fma_f32 v[110:111], v[190:191], v[170:171], v[110:111] op_sel_hi:[1,0,1]
    v_pk_mul_f32 v[108:109], v[108:109], v[180:181]
    v_pk_mul_f32 v[110:111], v[110:111], v[182:183]
    v_cvt_pk_bf16_f32 v111, v110, v111
    v_cvt_pk_bf16_f32 v110, v108, v109
    v_pk_fma_f32 v[112:113], v[192:193], v[170:171], v[112:113] op_sel_hi:[1,0,1]
    v_pk_fma_f32 v[114:115], v[194:195], v[170:171], v[114:115] op_sel_hi:[1,0,1]
    v_pk_mul_f32 v[112:113], v[112:113], v[184:185]
    v_pk_mul_f32 v[114:115], v[114:115], v[186:187]
    v_cvt_pk_bf16_f32 v112, v112, v113
    v_cvt_pk_bf16_f32 v113, v114, v115
    ds_write_b128 v228, v[110:113] offset:8192
    v_pk_fma_f32 v[116:117], v[188:189], v[172:173], v[116:117] op_sel_hi:[1,0,1]
    v_pk_fma_f32 v[118:119], v[190:191], v[172:173], v[118:119] op_sel_hi:[1,0,1]
    v_pk_mul_f32 v[116:117], v[116:117], v[180:181]
    v_pk_mul_f32 v[118:119], v[118:119], v[182:183]
    v_cvt_pk_bf16_f32 v119, v118, v119
    v_cvt_pk_bf16_f32 v118, v116, v117
    v_pk_fma_f32 v[120:121], v[192:193], v[172:173], v[120:121] op_sel_hi:[1,0,1]
    v_pk_fma_f32 v[122:123], v[194:195], v[172:173], v[122:123] op_sel_hi:[1,0,1]
    v_pk_mul_f32 v[120:121], v[120:121], v[184:185]
    v_pk_mul_f32 v[122:123], v[122:123], v[186:187]
    v_cvt_pk_bf16_f32 v120, v120, v121
    v_cvt_pk_bf16_f32 v121, v122, v123
    ds_write_b128 v228, v[118:121] offset:9216
    v_pk_fma_f32 v[4:5], v[144:145], v[220:221], v[4:5] op_sel:[0,1,0] op_sel_hi:[1,1,1]
    v_pk_fma_f32 v[6:7], v[146:147], v[220:221], v[6:7] op_sel:[0,1,0] op_sel_hi:[1,1,1]
    v_cvt_pk_bf16_f32 v4, v4, v5
    v_cvt_pk_bf16_f32 v5, v6, v7
    v_pk_fma_f32 v[8:9], v[148:149], v[220:221], v[8:9] op_sel:[0,1,0] op_sel_hi:[1,1,1]
    v_pk_fma_f32 v[10:11], v[150:151], v[220:221], v[10:11] op_sel:[0,1,0] op_sel_hi:[1,1,1]
    v_cvt_pk_bf16_f32 v8, v8, v9
    v_cvt_pk_bf16_f32 v9, v10, v11
    v_cndmask_b32 v6, v8, v213, s[42:43]
    v_cndmask_b32 v7, v9, v213, s[42:43]
    v_cndmask_b32 v8, v213, v8, s[42:43]
    v_cndmask_b32 v9, v213, v9, s[42:43]
    v_pk_fma_f32 v[12:13], v[152:153], v[220:221], v[12:13] op_sel:[0,1,0] op_sel_hi:[1,1,1]
    v_pk_fma_f32 v[14:15], v[154:155], v[220:221], v[14:15] op_sel:[0,1,0] op_sel_hi:[1,1,1]
    v_cvt_pk_bf16_f32 v12, v12, v13
    v_cvt_pk_bf16_f32 v13, v14, v15
    v_cndmask_b32 v10, v12, v213, s[44:45]
    v_cndmask_b32 v11, v13, v213, s[44:45]
    v_cndmask_b32 v12, v213, v12, s[44:45]
    v_cndmask_b32 v13, v213, v13, s[44:45]
    v_pk_fma_f32 v[16:17], v[156:157], v[220:221], v[16:17] op_sel:[0,1,0] op_sel_hi:[1,1,1]
    v_pk_fma_f32 v[18:19], v[158:159], v[220:221], v[18:19] op_sel:[0,1,0] op_sel_hi:[1,1,1]
    v_cvt_pk_bf16_f32 v16, v16, v17
    v_cvt_pk_bf16_f32 v17, v18, v19
    v_cndmask_b32 v14, v16, v213, s[46:47]
    v_cndmask_b32 v15, v17, v213, s[46:47]
    v_cndmask_b32 v16, v213, v16, s[46:47]
    v_cndmask_b32 v17, v213, v17, s[46:47]
    v_pk_fma_f32 v[20:21], v[160:161], v[220:221], v[20:21] op_sel:[0,1,0] op_sel_hi:[1,1,1]
    v_pk_fma_f32 v[22:23], v[162:163], v[220:221], v[22:23] op_sel:[0,1,0] op_sel_hi:[1,1,1]
    v_cvt_pk_bf16_f32 v18, v20, v21
    v_cvt_pk_bf16_f32 v19, v22, v23
    v_mul_f32 v220, 0x3ea52b5c, v220
    ds_write_b128 v228, v[4:7] offset:10240
    ds_write_b128 v228, v[8:11] offset:11264
    ds_write_b128 v228, v[12:15] offset:12288
    ds_write_b128 v228, v[16:19] offset:13312
    v_lshlrev_b32 v217, 2, v0
    v_add_u32 v217, s50, v217
    ds_write_b32 v217, v220 offset:14336
    s_waitcnt lgkmcnt(0)
    s_barrier
    v_pk_fma_f32 v[24:25], v[144:145], v[222:223], v[24:25] op_sel:[0,1,0] op_sel_hi:[1,1,1]
    v_pk_fma_f32 v[26:27], v[146:147], v[222:223], v[26:27] op_sel:[0,1,0] op_sel_hi:[1,1,1]
    v_cvt_pk_bf16_f32 v24, v24, v25
    v_cvt_pk_bf16_f32 v25, v26, v27
    v_pk_fma_f32 v[28:29], v[148:149], v[222:223], v[28:29] op_sel:[0,1,0] op_sel_hi:[1,1,1]
    v_pk_fma_f32 v[30:31], v[150:151], v[222:223], v[30:31] op_sel:[0,1,0] op_sel_hi:[1,1,1]
    v_cvt_pk_bf16_f32 v28, v28, v29
    v_cvt_pk_bf16_f32 v29, v30, v31
    v_cndmask_b32 v26, v28, v213, s[42:43]
    v_cndmask_b32 v27, v29, v213, s[42:43]
    v_cndmask_b32 v28, v213, v28, s[42:43]
    v_cndmask_b32 v29, v213, v29, s[42:43]
    v_pk_fma_f32 v[32:33], v[152:153], v[222:223], v[32:33] op_sel:[0,1,0] op_sel_hi:[1,1,1]
    v_pk_fma_f32 v[34:35], v[154:155], v[222:223], v[34:35] op_sel:[0,1,0] op_sel_hi:[1,1,1]
    v_cvt_pk_bf16_f32 v32, v32, v33
    v_cvt_pk_bf16_f32 v33, v34, v35
    v_cndmask_b32 v30, v32, v213, s[44:45]
    v_cndmask_b32 v31, v33, v213, s[44:45]
    v_cndmask_b32 v32, v213, v32, s[44:45]
    v_cndmask_b32 v33, v213, v33, s[44:45]
    v_pk_fma_f32 v[36:37], v[156:157], v[222:223], v[36:37] op_sel:[0,1,0] op_sel_hi:[1,1,1]
    v_pk_fma_f32 v[38:39], v[158:159], v[222:223], v[38:39] op_sel:[0,1,0] op_sel_hi:[1,1,1]
    v_cvt_pk_bf16_f32 v36, v36, v37
    v_cvt_pk_bf16_f32 v37, v38, v39
    v_cndmask_b32 v34, v36, v213, s[46:47]
    v_cndmask_b32 v35, v37, v213, s[46:47]
    v_cndmask_b32 v36, v213, v36, s[46:47]
    v_cndmask_b32 v37, v213, v37, s[46:47]
    v_pk_fma_f32 v[40:41], v[160:161], v[222:223], v[40:41] op_sel:[0,1,0] op_sel_hi:[1,1,1]
    v_pk_fma_f32 v[42:43], v[162:163], v[222:223], v[42:43] op_sel:[0,1,0] op_sel_hi:[1,1,1]
    v_cvt_pk_bf16_f32 v38, v40, v41
    v_cvt_pk_bf16_f32 v39, v42, v43
    v_mul_f32 v222, 0x3ea52b5c, v222
    s_barrier
    v_mfma_f32_16x16x32_bf16 v[124:127], v[44:47], v[24:27], 0
    v_mfma_f32_16x16x32_bf16 v[128:131], v[64:67], v[24:27], 0
    v_mfma_f32_16x16x32_bf16 v[132:135], v[46:49], v[28:31], 0
    v_mfma_f32_16x16x32_bf16 v[136:139], v[66:69], v[28:31], 0
    v_mfma_f32_16x16x32_bf16 v[140:143], v[48:51], v[32:35], 0
    v_mfma_f32_16x16x32_bf16 v[144:147], v[68:71], v[32:35], 0
    v_mfma_f32_16x16x32_bf16 v[148:151], v[50:53], v[36:39], 0
    v_mfma_f32_16x16x32_bf16 v[152:155], v[70:73], v[36:39], 0
    s_mul_i32 s54, s33, 7
    s_lshl_b32 s55, s36, 1
    s_add_u32 s54, s54, s55
    s_lshr_b32 s55, s54, 2
    s_mul_i32 s55, s55, 278528
    s_and_b32 s56, s54, 3
    s_lshl_b32 s56, s56, 10
    s_add_u32 s58, s56, s55
    s_mul_i32 s55, s34, 5
    v_pk_fma_f32 v[124:125], v[124:125], v[222:223], v[200:201] op_sel_hi:[1,0,1]
    v_pk_fma_f32 v[126:127], v[126:127], v[222:223], v[202:203] op_sel_hi:[1,0,1]
    v_pk_fma_f32 v[128:129], v[128:129], v[222:223], v[204:205] op_sel_hi:[1,0,1]
    v_pk_fma_f32 v[130:131], v[130:131], v[222:223], v[206:207] op_sel_hi:[1,0,1]
    v_pk_fma_f32 v[132:133], v[132:133], v[222:223], v[200:201] op_sel_hi:[1,0,1]
    v_pk_fma_f32 v[134:135], v[134:135], v[222:223], v[202:203] op_sel_hi:[1,0,1]
    v_pk_fma_f32 v[136:137], v[136:137], v[222:223], v[204:205] op_sel_hi:[1,0,1]
    v_pk_fma_f32 v[138:139], v[138:139], v[222:223], v[206:207] op_sel_hi:[1,0,1]
    v_pk_fma_f32 v[140:141], v[140:141], v[222:223], v[200:201] op_sel_hi:[1,0,1]
    v_pk_fma_f32 v[142:143], v[142:143], v[222:223], v[202:203] op_sel_hi:[1,0,1]
    v_pk_fma_f32 v[144:145], v[144:145], v[222:223], v[204:205] op_sel_hi:[1,0,1]
    v_pk_fma_f32 v[146:147], v[146:147], v[222:223], v[206:207] op_sel_hi:[1,0,1]
    v_pk_fma_f32 v[148:149], v[148:149], v[222:223], v[200:201] op_sel_hi:[1,0,1]
    v_pk_fma_f32 v[150:151], v[150:151], v[222:223], v[202:203] op_sel_hi:[1,0,1]
    v_pk_fma_f32 v[152:153], v[152:153], v[222:223], v[204:205] op_sel_hi:[1,0,1]
    v_pk_fma_f32 v[154:155], v[154:155], v[222:223], v[206:207] op_sel_hi:[1,0,1]
    v_max3_f32 v172, v124, v125, v126
    v_max3_f32 v173, v127, v128, v129
    v_max3_f32 v172, v172, v130, v131
    v_max_f32 v172, v172, v173
    v_mov_b32 v173, v172
    v_max3_f32 v174, v132, v133, v134
    v_max3_f32 v175, v135, v136, v137
    v_max3_f32 v174, v174, v138, v139
    v_max_f32 v174, v174, v175
    v_mov_b32 v175, v174
    v_max3_f32 v176, v140, v141, v142
    v_max3_f32 v177, v143, v144, v145
    v_max3_f32 v176, v176, v146, v147
    v_max_f32 v176, v176, v177
    v_mov_b32 v177, v176
    v_max3_f32 v178, v148, v149, v150
    v_max3_f32 v179, v151, v152, v153
    v_max3_f32 v178, v178, v154, v155
    v_max_f32 v178, v178, v179
    v_mov_b32 v179, v178
    v_permlane32_swap_b32 v172, v173
    v_permlane32_swap_b32 v174, v175
    v_permlane32_swap_b32 v176, v177
    v_permlane32_swap_b32 v178, v179
    v_max_f32 v172, v172, v173
    v_mov_b32 v173, v172
    v_max_f32 v174, v174, v175
    v_mov_b32 v175, v174
    v_max_f32 v176, v176, v177
    v_mov_b32 v177, v176
    v_max_f32 v178, v178, v179
    v_mov_b32 v179, v178
    v_permlane16_swap_b32 v172, v173
    v_permlane16_swap_b32 v174, v175
    v_permlane16_swap_b32 v176, v177
    v_permlane16_swap_b32 v178, v179
    v_max_f32 v172, v172, v173
    v_max_f32 v174, v174, v175
    v_max_f32 v176, v176, v177
    v_max_f32 v178, v178, v179
    v_pk_add_f32 v[124:125], v[124:125], v[172:173] op_sel_hi:[1,0] neg_lo:[0,1] neg_hi:[0,1]
    v_pk_add_f32 v[126:127], v[126:127], v[172:173] op_sel_hi:[1,0] neg_lo:[0,1] neg_hi:[0,1]
    v_pk_add_f32 v[128:129], v[128:129], v[172:173] op_sel_hi:[1,0] neg_lo:[0,1] neg_hi:[0,1]
    v_pk_add_f32 v[130:131], v[130:131], v[172:173] op_sel_hi:[1,0] neg_lo:[0,1] neg_hi:[0,1]
    v_exp_f32 v124, v124
    v_exp_f32 v125, v125
    v_exp_f32 v126, v126
    v_exp_f32 v127, v127
    v_exp_f32 v128, v128
    v_exp_f32 v129, v129
    v_exp_f32 v130, v130
    v_exp_f32 v131, v131
    v_pk_add_f32 v[132:133], v[132:133], v[174:175] op_sel_hi:[1,0] neg_lo:[0,1] neg_hi:[0,1]
    v_pk_add_f32 v[134:135], v[134:135], v[174:175] op_sel_hi:[1,0] neg_lo:[0,1] neg_hi:[0,1]
    v_pk_add_f32 v[136:137], v[136:137], v[174:175] op_sel_hi:[1,0] neg_lo:[0,1] neg_hi:[0,1]
    v_pk_add_f32 v[138:139], v[138:139], v[174:175] op_sel_hi:[1,0] neg_lo:[0,1] neg_hi:[0,1]
    v_exp_f32 v132, v132
    v_exp_f32 v133, v133
    v_exp_f32 v134, v134
    v_exp_f32 v135, v135
    v_exp_f32 v136, v136
    v_exp_f32 v137, v137
    v_exp_f32 v138, v138
    v_exp_f32 v139, v139
    v_cvt_pk_bf16_f32 v156, v124, v125
    v_cvt_pk_bf16_f32 v157, v126, v127
    v_cvt_pk_bf16_f32 v158, v128, v129
    v_cvt_pk_bf16_f32 v159, v130, v131
    s_nop 1
    v_mfma_f32_16x16x32_bf16 v[4:7], v[196:199], v[156:159], 0
    v_mfma_f32_16x16x32_bf16 v[124:127], v[86:89], v[156:159], 0
    v_mfma_f32_16x16x32_bf16 v[128:131], v[94:97], v[156:159], 0
    v_pk_add_f32 v[140:141], v[140:141], v[176:177] op_sel_hi:[1,0] neg_lo:[0,1] neg_hi:[0,1]
    v_pk_add_f32 v[142:143], v[142:143], v[176:177] op_sel_hi:[1,0] neg_lo:[0,1] neg_hi:[0,1]
    v_pk_add_f32 v[144:145], v[144:145], v[176:177] op_sel_hi:[1,0] neg_lo:[0,1] neg_hi:[0,1]
    v_pk_add_f32 v[146:147], v[146:147], v[176:177] op_sel_hi:[1,0] neg_lo:[0,1] neg_hi:[0,1]
    v_exp_f32 v140, v140
    v_exp_f32 v141, v141
    v_exp_f32 v142, v142
    v_exp_f32 v143, v143
    v_exp_f32 v144, v144
    v_exp_f32 v145, v145
    v_exp_f32 v146, v146
    v_exp_f32 v147, v147
    v_cvt_pk_bf16_f32 v160, v132, v133
    v_cvt_pk_bf16_f32 v161, v134, v135
    v_cvt_pk_bf16_f32 v162, v136, v137
    v_cvt_pk_bf16_f32 v163, v138, v139
    s_nop 1
    v_mfma_f32_16x16x32_bf16 v[8:11], v[196:199], v[160:163], 0
    v_mfma_f32_16x16x32_bf16 v[132:135], v[94:97], v[160:163], 0
    v_mfma_f32_16x16x32_bf16 v[136:139], v[102:105], v[160:163], 0
    v_pk_add_f32 v[148:149], v[148:149], v[178:179] op_sel_hi:[1,0] neg_lo:[0,1] neg_hi:[0,1]
    v_pk_add_f32 v[150:151], v[150:151], v[178:179] op_sel_hi:[1,0] neg_lo:[0,1] neg_hi:[0,1]
    v_pk_add_f32 v[152:153], v[152:153], v[178:179] op_sel_hi:[1,0] neg_lo:[0,1] neg_hi:[0,1]
    v_pk_add_f32 v[154:155], v[154:155], v[178:179] op_sel_hi:[1,0] neg_lo:[0,1] neg_hi:[0,1]
    v_exp_f32 v148, v148
    v_exp_f32 v149, v149
    v_exp_f32 v150, v150
    v_exp_f32 v151, v151
    v_exp_f32 v152, v152
    v_exp_f32 v153, v153
    v_exp_f32 v154, v154
    v_exp_f32 v155, v155
    v_cvt_pk_bf16_f32 v164, v140, v141
    v_cvt_pk_bf16_f32 v165, v142, v143
    v_cvt_pk_bf16_f32 v166, v144, v145
    v_cvt_pk_bf16_f32 v167, v146, v147
    s_nop 1
    v_mfma_f32_16x16x32_bf16 v[12:15], v[196:199], v[164:167], 0
    v_mfma_f32_16x16x32_bf16 v[140:143], v[102:105], v[164:167], 0
    v_mfma_f32_16x16x32_bf16 v[144:147], v[110:113], v[164:167], 0
    v_cvt_pk_bf16_f32 v168, v148, v149
    v_cvt_pk_bf16_f32 v169, v150, v151
    v_cvt_pk_bf16_f32 v170, v152, v153
    v_cvt_pk_bf16_f32 v171, v154, v155
    s_nop 1
    v_mfma_f32_16x16x32_bf16 v[16:19], v[196:199], v[168:171], 0
    v_mfma_f32_16x16x32_bf16 v[148:151], v[110:113], v[168:171], 0
    v_mfma_f32_16x16x32_bf16 v[152:155], v[118:121], v[168:171], 0
    v_rcp_f32 v4, v4
    s_nop 0
    v_pk_mul_f32 v[124:125], v[124:125], v[4:5] op_sel_hi:[1,0]
    v_pk_mul_f32 v[126:127], v[126:127], v[4:5] op_sel_hi:[1,0]
    v_cvt_pk_bf16_f32 v182, v124, v125
    v_cvt_pk_bf16_f32 v183, v126, v127
    v_rcp_f32 v8, v8
    v_cndmask_b32 v132, v128, v132, s[42:43]
    v_cndmask_b32 v133, v129, v133, s[42:43]
    v_cndmask_b32 v134, v130, v134, s[42:43]
    v_cndmask_b32 v135, v131, v135, s[42:43]
    v_cndmask_b32 v20, v4, v8, s[42:43]
    v_pk_mul_f32 v[132:133], v[132:133], v[20:21] op_sel_hi:[1,0]
    v_pk_mul_f32 v[134:135], v[134:135], v[20:21] op_sel_hi:[1,0]
    v_cvt_pk_bf16_f32 v184, v132, v133
    v_cvt_pk_bf16_f32 v185, v134, v135
    v_rcp_f32 v12, v12
    v_cndmask_b32 v140, v136, v140, s[44:45]
    v_cndmask_b32 v141, v137, v141, s[44:45]
    v_cndmask_b32 v142, v138, v142, s[44:45]
    v_cndmask_b32 v143, v139, v143, s[44:45]
    v_cndmask_b32 v20, v8, v12, s[44:45]
    v_pk_mul_f32 v[140:141], v[140:141], v[20:21] op_sel_hi:[1,0]
    v_pk_mul_f32 v[142:143], v[142:143], v[20:21] op_sel_hi:[1,0]
    v_cvt_pk_bf16_f32 v186, v140, v141
    v_cvt_pk_bf16_f32 v187, v142, v143
    v_rcp_f32 v16, v16
    v_cndmask_b32 v148, v144, v148, s[46:47]
    v_cndmask_b32 v149, v145, v149, s[46:47]
    v_cndmask_b32 v150, v146, v150, s[46:47]
    v_cndmask_b32 v151, v147, v151, s[46:47]
    v_cndmask_b32 v20, v12, v16, s[46:47]
    v_pk_mul_f32 v[148:149], v[148:149], v[20:21] op_sel_hi:[1,0]
    v_pk_mul_f32 v[150:151], v[150:151], v[20:21] op_sel_hi:[1,0]
    v_cvt_pk_bf16_f32 v188, v148, v149
    v_cvt_pk_bf16_f32 v189, v150, v151
    v_pk_mul_f32 v[152:153], v[152:153], v[16:17] op_sel_hi:[1,0]
    v_pk_mul_f32 v[154:155], v[154:155], v[16:17] op_sel_hi:[1,0]
    v_cvt_pk_bf16_f32 v190, v152, v153
    v_cvt_pk_bf16_f32 v191, v154, v155
    v_and_b32 v172, 16, v0
    v_lshlrev_b32 v172, 5, v172
    v_and_b32 v173, 32, v0
    v_lshl_add_u32 v172, v173, 3, v172
    v_and_b32 v173, 15, v0
    v_lshl_add_u32 v172, v173, 4, v172
    s_cmp_ge_u32 s54, 128
    s_cbranch_scc1 att_nost_51
    s_lshr_b32 s57, s55, 1
    s_lshl_b32 s57, s57, 12
    s_add_u32 s58, s58, s57
    s_add_u32 s59, s58, 4096
    s_add_u32 s60, s58, 8192
    s_bitcmp1_b32 s34, 0
    s_cbranch_scc1 att_odd_52
    v_permlane16_swap_b32 v182, v184
    v_permlane16_swap_b32 v183, v185
    v_permlane16_swap_b32 v186, v188
    v_permlane16_swap_b32 v187, v189
    v_permlane16_swap_b32 v190, v192
    v_permlane16_swap_b32 v191, v193
    buffer_store_dwordx4 v[182:185], v172, s[24:27], s58 offen sc1
    buffer_store_dwordx4 v[186:189], v172, s[24:27], s59 offen sc1
    s_mov_b32 exec_lo, 0xffff
    s_mov_b32 exec_hi, 0xffff
    buffer_store_dwordx4 v[190:193], v172, s[24:27], s60 offen sc1
    s_mov_b64 exec, -1
    s_branch att_fl_53
att_odd_52:
    v_permlane16_swap_b32 v180, v182
    v_permlane16_swap_b32 v181, v183
    v_permlane16_swap_b32 v184, v186
    v_permlane16_swap_b32 v185, v187
    v_permlane16_swap_b32 v188, v190
    v_permlane16_swap_b32 v189, v191
    s_mov_b32 exec_lo, 0xffff0000
    s_mov_b32 exec_hi, 0xffff0000
    buffer_store_dwordx4 v[180:183], v172, s[24:27], s58 offen sc1
    s_mov_b64 exec, -1
    buffer_store_dwordx4 v[184:187], v172, s[24:27], s59 offen sc1
    buffer_store_dwordx4 v[188:191], v172, s[24:27], s60 offen sc1
att_fl_53:
    s_lshl_b32 s54, s54, 5
    s_lshl_b32 s55, s34, 2
    s_add_u32 s54, s54, s55
    s_add_u32 s54, s54, 0xb28000
    v_mov_b32 v20, s54
    v_mov_b32 v21, s73
    s_waitcnt vmcnt(0)
    s_mov_b64 exec, 1
    buffer_store_dword v21, v20, s[24:27], 0 offen sc1
    s_mov_b64 exec, -1
att_nost_51:
    s_branch p2_compute
k_cB:
    s_waitcnt lgkmcnt(0)
    s_mov_b32 s8, s4
    s_and_b32 s9, s5, 0xffff
    s_mov_b32 s10, 0x280000
    s_mov_b32 s11, 0x20000
    s_mov_b32 s24, s20
    s_and_b32 s25, s21, 0xffff
    s_mov_b32 s26, 0xb33000
    s_mov_b32 s27, 0x20000
    v_lshrrev_b32 v230, 5, v0
    v_mul_u32_u24 v230, 0x500, v230
    v_and_b32 v231, 31, v0
    v_lshl_add_u32 v230, v231, 4, v230
    s_lshl_b32 s50, s81, 2
    s_add_u32 s50, s50, s36
    s_mul_i32 s50, s50, 2560
    v_mov_b32 v156, 0
    v_mov_b32 v157, 0
    v_mov_b32 v158, 0
    v_mov_b32 v159, 0
    buffer_load_dwordx4 v[148:151], v230, s[8:11], s50 offen
    buffer_load_dwordx4 v[152:155], v230, s[8:11], s50 offen offset:512
    s_mov_b32 exec_lo, 0xffff
    s_mov_b32 exec_hi, 0xffff
    buffer_load_dwordx4 v[156:159], v230, s[8:11], s50 offen offset:1024
    s_mov_b64 exec, -1
    s_lshl_b32 s50, s2, 2
    s_add_u32 s50, s50, s36
    s_cmp_lg_u32 s50, 3
    s_cbranch_scc1 no_nonce_54
    s_memrealtime s[50:51]
    s_mov_b32 s52, s90
    s_and_b32 s53, s91, 0xffff
    s_mov_b32 s54, 0x100
    s_mov_b32 s55, 0x20000
    v_mov_b32 v230, 0
    s_waitcnt lgkmcnt(0)
    s_or_b32 s50, s50, 1
    v_mov_b32 v231, s50
    s_mov_b64 exec, 1
    buffer_store_dword v231, v230, s[52:55], 0 offen sc1
    s_mov_b64 exec, -1
no_nonce_54:
    s_lshr_b32 s40, s36, 1
    s_and_b32 s41, s36, 1
    v_lshrrev_b32 v228, 4, v0
    v_and_b32 v229, 15, v0
    v_lshrrev_b32 v230, 1, v229
    v_xor_b32 v230, v230, v228
    v_lshlrev_b32 v230, 4, v230
    v_lshl_add_u32 v230, v229, 7, v230
    s_mul_i32 s50, s40, 10240
    v_add_u32 v208, s50, v230
    v_xor_b32 v209, 64, v208
    v_lshrrev_b32 v230, 1, v228
    v_lshlrev_b32 v230, 4, v230
    v_and_b32 v231, 1, v228
    v_lshl_add_u32 v230, v231, 2, v230
    v_lshrrev_b32 v231, 2, v229
    v_add_u32 v230, v230, v231
    v_bfe_u32 v232, v230, 1, 2
    v_mul_u32_u24 v230, 384, v230
    v_and_b32 v231, 3, v0
    v_lshl_add_u32 v230, v231, 3, v230
    v_add_u32 v230, 20480, v230
    s_mul_i32 s50, s41, 6
    s_cmp_eq_u32 s40, 0
    s_cselect_b32 s52, 0, 4
    s_add_u32 s42, s52, s50
    v_xor_b32 v231, s42, v232
    v_lshl_add_u32 v210, v231, 5, v230
    s_cmp_eq_u32 s40, 0
    s_cselect_b32 s52, 1, 5
    s_add_u32 s43, s52, s50
    v_xor_b32 v231, s43, v232
    v_lshl_add_u32 v211, v231, 5, v230
    s_cmp_eq_u32 s40, 0
    s_cselect_b32 s52, 2, 2
    s_add_u32 s44, s52, s50
    v_xor_b32 v231, s44, v232
    v_lshl_add_u32 v212, v231, 5, v230
    s_cmp_eq_u32 s40, 0
    s_cselect_b32 s52, 3, 3
    s_add_u32 s45, s52, s50
    v_xor_b32 v231, s45, v232
    v_lshl_add_u32 v213, v231, 5, v230
    s_cmp_eq_u32 s40, 0
    s_cselect_b32 s52, 4, 0
    s_add_u32 s46, s52, s50
    v_xor_b32 v231, s46, v232
    v_lshl_add_u32 v214, v231, 5, v230
    s_cmp_eq_u32 s40, 0
    s_cselect_b32 s52, 5, 1
    s_add_u32 s47, s52, s50
    v_xor_b32 v231, s47, v232
    v_lshl_add_u32 v215, v231, 5, v230
    v_mov_b32 v204, 0x3f803f80
    v_mov_b32 v205, 0x3f803f80
    v_mov_b32 v206, 0x3f803f80
    v_mov_b32 v207, 0x3f803f80
    v_mov_b32 v4, 0
    v_mov_b32 v5, 0
    v_mov_b32 v6, 0
    v_mov_b32 v7, 0
    v_mov_b32 v8, 0
    v_mov_b32 v9, 0
    v_mov_b32 v10, 0
    v_mov_b32 v11, 0
    v_mov_b32 v12, 0
    v_mov_b32 v13, 0
    v_mov_b32 v14, 0
    v_mov_b32 v15, 0
    v_mov_b32 v16, 0
    v_mov_b32 v17, 0
    v_mov_b32 v18, 0
    v_mov_b32 v19, 0
    v_mov_b32 v20, 0
    v_mov_b32 v21, 0
    v_mov_b32 v22, 0
    v_mov_b32 v23, 0
    v_mov_b32 v24, 0
    v_mov_b32 v25, 0
    v_mov_b32 v26, 0
    v_mov_b32 v27, 0
    v_mov_b32 v28, 0
    v_mov_b32 v29, 0
    v_mov_b32 v30, 0
    v_mov_b32 v31, 0
    v_mov_b32 v32, 0
    v_mov_b32 v33, 0
    v_mov_b32 v34, 0
    v_mov_b32 v35, 0
    v_mov_b32 v36, 0
    v_mov_b32 v37, 0
    v_mov_b32 v38, 0
    v_mov_b32 v39, 0
    v_mov_b32 v40, 0
    v_mov_b32 v41, 0
    v_mov_b32 v42, 0
    v_mov_b32 v43, 0
    v_mov_b32 v44, 0
    v_mov_b32 v45, 0
    v_mov_b32 v46, 0
    v_mov_b32 v47, 0
    v_mov_b32 v48, 0
    v_mov_b32 v49, 0
    v_mov_b32 v50, 0
    v_mov_b32 v51, 0
    v_mov_b32 v52, 0
    v_mov_b32 v53, 0
    v_mov_b32 v54, 0
    v_mov_b32 v55, 0
    v_mov_b32 v56, 0
    v_mov_b32 v57, 0
    v_mov_b32 v58, 0
    v_mov_b32 v59, 0
    v_mov_b32 v60, 0
    v_mov_b32 v61, 0
    v_mov_b32 v62, 0
    v_mov_b32 v63, 0
    v_mov_b32 v64, 0
    v_mov_b32 v65, 0
    v_mov_b32 v66, 0
    v_mov_b32 v67, 0
    v_mov_b32 v68, 0
    v_mov_b32 v69, 0
    v_mov_b32 v70, 0
    v_mov_b32 v71, 0
    v_mov_b32 v72, 0
    v_mov_b32 v73, 0
    v_mov_b32 v74, 0
    v_mov_b32 v75, 0
    v_mov_b32 v76, 0
    v_mov_b32 v77, 0
    v_mov_b32 v78, 0
    v_mov_b32 v79, 0
    v_mov_b32 v80, 0
    v_mov_b32 v81, 0
    v_mov_b32 v82, 0
    v_mov_b32 v83, 0
    v_mov_b32 v84, 0
    v_mov_b32 v85, 0
    v_mov_b32 v86, 0
    v_mov_b32 v87, 0
    v_mov_b32 v88, 0
    v_mov_b32 v89, 0
    v_mov_b32 v90, 0
    v_mov_b32 v91, 0
    v_mov_b32 v92, 0
    v_mov_b32 v93, 0
    v_mov_b32 v94, 0
    v_mov_b32 v95, 0
    v_mov_b32 v96, 0
    v_mov_b32 v97, 0
    v_mov_b32 v98, 0
    v_mov_b32 v99, 0
    v_mov_b32 v100, 0
    v_mov_b32 v101, 0
    v_mov_b32 v102, 0
    v_mov_b32 v103, 0
    v_mov_b32 v104, 0
    v_mov_b32 v105, 0
    v_mov_b32 v106, 0
    v_mov_b32 v107, 0
    v_mov_b32 v108, 0
    v_mov_b32 v109, 0
    v_mov_b32 v110, 0
    v_mov_b32 v111, 0
    v_mov_b32 v112, 0
    v_mov_b32 v113, 0
    v_mov_b32 v114, 0
    v_mov_b32 v115, 0
    v_mov_b32 v116, 0
    v_mov_b32 v117, 0
    v_mov_b32 v118, 0
    v_mov_b32 v119, 0
    v_mov_b32 v120, 0
    v_mov_b32 v121, 0
    v_mov_b32 v122, 0
    v_mov_b32 v123, 0
    v_mov_b32 v124, 0
    v_mov_b32 v125, 0
    v_mov_b32 v126, 0
    v_mov_b32 v127, 0
    v_mov_b32 v128, 0
    v_mov_b32 v129, 0
    v_mov_b32 v130, 0
    v_mov_b32 v131, 0
    v_mov_b32 v132, 0
    v_mov_b32 v133, 0
    v_mov_b32 v134, 0
    v_mov_b32 v135, 0
    v_mov_b32 v160, 0
    v_mov_b32 v162, 0
    s_waitcnt vmcnt(0)
    v_lshlrev_b32 v164, 16, v148
    v_and_b32 v165, 0xffff0000, v148
    v_add_f32 v160, v160, v164
    v_fmac_f32 v162, v164, v164
    v_add_f32 v160, v160, v165
    v_fmac_f32 v162, v165, v165
    v_lshlrev_b32 v164, 16, v149
    v_and_b32 v165, 0xffff0000, v149
    v_add_f32 v160, v160, v164
    v_fmac_f32 v162, v164, v164
    v_add_f32 v160, v160, v165
    v_fmac_f32 v162, v165, v165
    v_lshlrev_b32 v164, 16, v150
    v_and_b32 v165, 0xffff0000, v150
    v_add_f32 v160, v160, v164
    v_fmac_f32 v162, v164, v164
    v_add_f32 v160, v160, v165
    v_fmac_f32 v162, v165, v165
    v_lshlrev_b32 v164, 16, v151
    v_and_b32 v165, 0xffff0000, v151
    v_add_f32 v160, v160, v164
    v_fmac_f32 v162, v164, v164
    v_add_f32 v160, v160, v165
    v_fmac_f32 v162, v165, v165
    v_lshlrev_b32 v164, 16, v152
    v_and_b32 v165, 0xffff0000, v152
    v_add_f32 v160, v160, v164
    v_fmac_f32 v162, v164, v164
    v_add_f32 v160, v160, v165
    v_fmac_f32 v162, v165, v165
    v_lshlrev_b32 v164, 16, v153
    v_and_b32 v165, 0xffff0000, v153
    v_add_f32 v160, v160, v164
    v_fmac_f32 v162, v164, v164
    v_add_f32 v160, v160, v165
    v_fmac_f32 v162, v165, v165
    v_lshlrev_b32 v164, 16, v154
    v_and_b32 v165, 0xffff0000, v154
    v_add_f32 v160, v160, v164
    v_fmac_f32 v162, v164, v164
    v_add_f32 v160, v160, v165
    v_fmac_f32 v162, v165, v165
    v_lshlrev_b32 v164, 16, v155
    v_and_b32 v165, 0xffff0000, v155
    v_add_f32 v160, v160, v164
    v_fmac_f32 v162, v164, v164
    v_add_f32 v160, v160, v165
    v_fmac_f32 v162, v165, v165
    v_lshlrev_b32 v164, 16, v156
    v_and_b32 v165, 0xffff0000, v156
    v_add_f32 v160, v160, v164
    v_fmac_f32 v162, v164, v164
    v_add_f32 v160, v160, v165
    v_fmac_f32 v162, v165, v165
    v_lshlrev_b32 v164, 16, v157
    v_and_b32 v165, 0xffff0000, v157
    v_add_f32 v160, v160, v164
    v_fmac_f32 v162, v164, v164
    v_add_f32 v160, v160, v165
    v_fmac_f32 v162, v165, v165
    v_lshlrev_b32 v164, 16, v158
    v_and_b32 v165, 0xffff0000, v158
    v_add_f32 v160, v160, v164
    v_fmac_f32 v162, v164, v164
    v_add_f32 v160, v160, v165
    v_fmac_f32 v162, v165, v165
    v_lshlrev_b32 v164, 16, v159
    v_and_b32 v165, 0xffff0000, v159
    v_add_f32 v160, v160, v164
    v_fmac_f32 v162, v164, v164
    v_add_f32 v160, v160, v165
    v_fmac_f32 v162, v165, v165
    s_nop 0
    v_add_f32_dpp v160, v160, v160 quad_perm:[1,0,3,2] row_mask:0xf bank_mask:0xf
    v_add_f32_dpp v162, v162, v162 quad_perm:[1,0,3,2] row_mask:0xf bank_mask:0xf
    s_nop 0
    v_add_f32_dpp v160, v160, v160 quad_perm:[2,3,0,1] row_mask:0xf bank_mask:0xf
    v_add_f32_dpp v162, v162, v162 quad_perm:[2,3,0,1] row_mask:0xf bank_mask:0xf
    s_nop 0
    v_add_f32_dpp v160, v160, v160 row_half_mirror row_mask:0xf bank_mask:0xf
    v_add_f32_dpp v162, v162, v162 row_half_mirror row_mask:0xf bank_mask:0xf
    s_nop 0
    v_add_f32_dpp v160, v160, v160 row_mirror row_mask:0xf bank_mask:0xf
    v_add_f32_dpp v162, v162, v162 row_mirror row_mask:0xf bank_mask:0xf
    v_mov_b32 v161, v160
    v_mov_b32 v163, v162
    s_nop 0
    v_permlane16_swap_b32 v160, v161
    v_permlane16_swap_b32 v162, v163
    v_add_f32 v160, v160, v161
    v_add_f32 v162, v162, v163
    v_mul_f32 v165, 0xBACCCCCD, v160
    v_mul_f32 v164, 0x3ACCCCCD, v162
    v_fma_f32 v164, -v165, v165, v164
    v_max_f32 v164, 0, v164
    v_add_f32 v164, 0x3727c5ac, v164
    v_rsq_f32 v164, v164
    v_lshrrev_b32 v160, 5, v0
    v_lshlrev_b32 v160, 3, v160
    s_lshl_b32 s50, s36, 4
    s_add_u32 s50, s50, 142336
    v_add_u32 v160, s50, v160
    ds_write_b64 v160, v[164:165]
    s_waitcnt lgkmcnt(0)
    s_mov_b32 s61, 0
    s_mov_b32 s70, 0
    s_barrier
    ds_read_b128 v[148:151], v208 offset:0
    ds_read_b128 v[152:155], v208 offset:2048
    ds_read_b128 v[156:159], v208 offset:4096
    ds_read_b128 v[160:163], v208 offset:6144
    ds_read_b128 v[164:167], v208 offset:8192
    ds_read_b64_tr_b16 v[188:189], v210 offset:0
    ds_read_b64_tr_b16 v[190:191], v210 offset:3072
    ds_read_b64_tr_b16 v[192:193], v211 offset:0
    ds_read_b64_tr_b16 v[194:195], v211 offset:3072
    ds_read_b64_tr_b16 v[196:197], v212 offset:0
    ds_read_b64_tr_b16 v[198:199], v212 offset:3072
    s_cmp_eq_u32 s40, 1
    s_cbranch_scc1 cB_loop1_57
cB_loop0_56:
    s_waitcnt lgkmcnt(4)
    v_mfma_f32_16x16x32_bf16 v[4:7], v[188:191], v[148:151], v[4:7]
    ds_read_b64_tr_b16 v[200:201], v213 offset:0
    v_mfma_f32_16x16x32_bf16 v[28:31], v[188:191], v[152:155], v[28:31]
    ds_read_b64_tr_b16 v[202:203], v213 offset:3072
    s_add_u32 s61, s61, 1
    s_cmp_eq_u32 s61, 3
    v_mfma_f32_16x16x32_bf16 v[52:55], v[188:191], v[156:159], v[52:55]
    s_cselect_b32 s61, 0, s61
    s_mov_b32 s62, 45056
    v_mfma_f32_16x16x32_bf16 v[76:79], v[188:191], v[160:163], v[76:79]
    s_cselect_b32 s62, 0xfffea000, s62
    v_mfma_f32_16x16x32_bf16 v[100:103], v[188:191], v[164:167], v[100:103]
    v_mfma_f32_16x16x32_bf16 v[124:127], v[188:191], v[204:207], v[124:127]
    s_waitcnt lgkmcnt(4)
    v_mfma_f32_16x16x32_bf16 v[8:11], v[192:195], v[148:151], v[8:11]
    ds_read_b64_tr_b16 v[188:189], v214 offset:0
    v_mfma_f32_16x16x32_bf16 v[32:35], v[192:195], v[152:155], v[32:35]
    ds_read_b64_tr_b16 v[190:191], v214 offset:3072
    v_mfma_f32_16x16x32_bf16 v[56:59], v[192:195], v[156:159], v[56:59]
    ds_read_b128 v[168:171], v209 offset:0
    v_mfma_f32_16x16x32_bf16 v[80:83], v[192:195], v[160:163], v[80:83]
    ds_read_b128 v[172:175], v209 offset:2048
    v_mfma_f32_16x16x32_bf16 v[104:107], v[192:195], v[164:167], v[104:107]
    ds_read_b128 v[176:179], v209 offset:4096
    v_mfma_f32_16x16x32_bf16 v[128:131], v[192:195], v[204:207], v[128:131]
    s_waitcnt lgkmcnt(7)
    v_mfma_f32_16x16x32_bf16 v[12:15], v[196:199], v[148:151], v[12:15]
    ds_read_b64_tr_b16 v[192:193], v215 offset:0
    v_mfma_f32_16x16x32_bf16 v[36:39], v[196:199], v[152:155], v[36:39]
    ds_read_b64_tr_b16 v[194:195], v215 offset:3072
    v_mfma_f32_16x16x32_bf16 v[60:63], v[196:199], v[156:159], v[60:63]
    ds_read_b128 v[180:183], v209 offset:6144
    v_mfma_f32_16x16x32_bf16 v[84:87], v[196:199], v[160:163], v[84:87]
    ds_read_b128 v[184:187], v209 offset:8192
    v_mfma_f32_16x16x32_bf16 v[108:111], v[196:199], v[164:167], v[108:111]
    v_mfma_f32_16x16x32_bf16 v[132:135], v[196:199], v[204:207], v[132:135]
    s_waitcnt lgkmcnt(9)
    v_mfma_f32_16x16x32_bf16 v[16:19], v[200:203], v[148:151], v[16:19]
    ds_read_b64_tr_b16 v[196:197], v210 offset:12288
    v_mfma_f32_16x16x32_bf16 v[40:43], v[200:203], v[152:155], v[40:43]
    ds_read_b64_tr_b16 v[198:199], v210 offset:15360
    v_add_u32 v208, s62, v208
    v_add_u32 v209, s62, v209
    v_mfma_f32_16x16x32_bf16 v[64:67], v[200:203], v[156:159], v[64:67]
    v_mfma_f32_16x16x32_bf16 v[88:91], v[200:203], v[160:163], v[88:91]
    v_mfma_f32_16x16x32_bf16 v[112:115], v[200:203], v[164:167], v[112:115]
    s_waitcnt lgkmcnt(9)
    v_mfma_f32_16x16x32_bf16 v[20:23], v[188:191], v[148:151], v[20:23]
    ds_read_b64_tr_b16 v[200:201], v211 offset:12288
    v_mfma_f32_16x16x32_bf16 v[44:47], v[188:191], v[152:155], v[44:47]
    ds_read_b64_tr_b16 v[202:203], v211 offset:15360
    v_add_u32 v210, s62, v210
    v_mfma_f32_16x16x32_bf16 v[68:71], v[188:191], v[156:159], v[68:71]
    v_mfma_f32_16x16x32_bf16 v[92:95], v[188:191], v[160:163], v[92:95]
    v_mfma_f32_16x16x32_bf16 v[116:119], v[188:191], v[164:167], v[116:119]
    s_waitcnt lgkmcnt(6)
    v_mfma_f32_16x16x32_bf16 v[24:27], v[192:195], v[148:151], v[24:27]
    ds_read_b64_tr_b16 v[188:189], v212 offset:12288
    v_mfma_f32_16x16x32_bf16 v[48:51], v[192:195], v[152:155], v[48:51]
    ds_read_b64_tr_b16 v[190:191], v212 offset:15360
    v_add_u32 v211, s62, v211
    v_mfma_f32_16x16x32_bf16 v[72:75], v[192:195], v[156:159], v[72:75]
    v_mfma_f32_16x16x32_bf16 v[96:99], v[192:195], v[160:163], v[96:99]
    v_mfma_f32_16x16x32_bf16 v[120:123], v[192:195], v[164:167], v[120:123]
    s_waitcnt lgkmcnt(4)
    v_mfma_f32_16x16x32_bf16 v[4:7], v[196:199], v[168:171], v[4:7]
    ds_read_b64_tr_b16 v[192:193], v213 offset:12288
    v_mfma_f32_16x16x32_bf16 v[28:31], v[196:199], v[172:175], v[28:31]
    ds_read_b64_tr_b16 v[194:195], v213 offset:15360
    v_add_u32 v212, s62, v212
    v_mfma_f32_16x16x32_bf16 v[52:55], v[196:199], v[176:179], v[52:55]
    v_mfma_f32_16x16x32_bf16 v[76:79], v[196:199], v[180:183], v[76:79]
    v_mfma_f32_16x16x32_bf16 v[100:103], v[196:199], v[184:187], v[100:103]
    v_mfma_f32_16x16x32_bf16 v[124:127], v[196:199], v[204:207], v[124:127]
    s_waitcnt lgkmcnt(4)
    v_mfma_f32_16x16x32_bf16 v[8:11], v[200:203], v[168:171], v[8:11]
    ds_read_b64_tr_b16 v[196:197], v214 offset:12288
    v_mfma_f32_16x16x32_bf16 v[32:35], v[200:203], v[172:175], v[32:35]
    ds_read_b64_tr_b16 v[198:199], v214 offset:15360
    v_add_u32 v213, s62, v213
    v_mfma_f32_16x16x32_bf16 v[56:59], v[200:203], v[176:179], v[56:59]
    v_mfma_f32_16x16x32_bf16 v[80:83], v[200:203], v[180:183], v[80:83]
    v_mfma_f32_16x16x32_bf16 v[104:107], v[200:203], v[184:187], v[104:107]
    v_mfma_f32_16x16x32_bf16 v[128:131], v[200:203], v[204:207], v[128:131]
    s_waitcnt lgkmcnt(4)
    v_mfma_f32_16x16x32_bf16 v[12:15], v[188:191], v[168:171], v[12:15]
    ds_read_b64_tr_b16 v[200:201], v215 offset:12288
    v_mfma_f32_16x16x32_bf16 v[36:39], v[188:191], v[172:175], v[36:39]
    ds_read_b64_tr_b16 v[202:203], v215 offset:15360
    v_add_u32 v214, s62, v214
    v_mfma_f32_16x16x32_bf16 v[60:63], v[188:191], v[176:179], v[60:63]
    v_mfma_f32_16x16x32_bf16 v[84:87], v[188:191], v[180:183], v[84:87]
    v_mfma_f32_16x16x32_bf16 v[108:111], v[188:191], v[184:187], v[108:111]
    v_mfma_f32_16x16x32_bf16 v[132:135], v[188:191], v[204:207], v[132:135]
    s_waitcnt lgkmcnt(4)
    v_mfma_f32_16x16x32_bf16 v[16:19], v[192:195], v[168:171], v[16:19]
    v_add_u32 v215, s62, v215
    v_mfma_f32_16x16x32_bf16 v[40:43], v[192:195], v[172:175], v[40:43]
    v_mfma_f32_16x16x32_bf16 v[64:67], v[192:195], v[176:179], v[64:67]
    v_mfma_f32_16x16x32_bf16 v[88:91], v[192:195], v[180:183], v[88:91]
    v_mfma_f32_16x16x32_bf16 v[112:115], v[192:195], v[184:187], v[112:115]
    s_waitcnt lgkmcnt(0)
    s_barrier
    v_mfma_f32_16x16x32_bf16 v[20:23], v[196:199], v[168:171], v[20:23]
    ds_read_b128 v[148:151], v208 offset:0
    ds_read_b128 v[152:155], v208 offset:2048
    v_mfma_f32_16x16x32_bf16 v[44:47], v[196:199], v[172:175], v[44:47]
    ds_read_b128 v[156:159], v208 offset:4096
    ds_read_b128 v[160:163], v208 offset:6144
    v_mfma_f32_16x16x32_bf16 v[68:71], v[196:199], v[176:179], v[68:71]
    ds_read_b128 v[164:167], v208 offset:8192
    ds_read_b64_tr_b16 v[188:189], v210 offset:0
    v_mfma_f32_16x16x32_bf16 v[92:95], v[196:199], v[180:183], v[92:95]
    ds_read_b64_tr_b16 v[190:191], v210 offset:3072
    ds_read_b64_tr_b16 v[192:193], v211 offset:0
    v_mfma_f32_16x16x32_bf16 v[116:119], v[196:199], v[184:187], v[116:119]
    ds_read_b64_tr_b16 v[194:195], v211 offset:3072
    v_mfma_f32_16x16x32_bf16 v[24:27], v[200:203], v[168:171], v[24:27]
    ds_read_b64_tr_b16 v[196:197], v212 offset:0
    v_mfma_f32_16x16x32_bf16 v[48:51], v[200:203], v[172:175], v[48:51]
    ds_read_b64_tr_b16 v[198:199], v212 offset:3072
    v_mfma_f32_16x16x32_bf16 v[72:75], v[200:203], v[176:179], v[72:75]
    v_mfma_f32_16x16x32_bf16 v[96:99], v[200:203], v[180:183], v[96:99]
    v_mfma_f32_16x16x32_bf16 v[120:123], v[200:203], v[184:187], v[120:123]
    s_add_u32 s70, s70, 1
    s_cmp_lt_u32 s70, 10
    s_cbranch_scc1 cB_loop0_56
    s_branch cB_done_55
cB_loop1_57:
    s_waitcnt lgkmcnt(4)
    v_mfma_f32_16x16x32_bf16 v[4:7], v[188:191], v[148:151], v[4:7]
    ds_read_b64_tr_b16 v[200:201], v213 offset:0
    v_mfma_f32_16x16x32_bf16 v[28:31], v[188:191], v[152:155], v[28:31]
    ds_read_b64_tr_b16 v[202:203], v213 offset:3072
    s_add_u32 s61, s61, 1
    s_cmp_eq_u32 s61, 3
    v_mfma_f32_16x16x32_bf16 v[52:55], v[188:191], v[156:159], v[52:55]
    s_cselect_b32 s61, 0, s61
    s_mov_b32 s62, 45056
    v_mfma_f32_16x16x32_bf16 v[76:79], v[188:191], v[160:163], v[76:79]
    s_cselect_b32 s62, 0xfffea000, s62
    v_mfma_f32_16x16x32_bf16 v[100:103], v[188:191], v[164:167], v[100:103]
    v_mfma_f32_16x16x32_bf16 v[124:127], v[188:191], v[204:207], v[124:127]
    s_waitcnt lgkmcnt(4)
    v_mfma_f32_16x16x32_bf16 v[8:11], v[192:195], v[148:151], v[8:11]
    ds_read_b64_tr_b16 v[188:189], v214 offset:0
    v_mfma_f32_16x16x32_bf16 v[32:35], v[192:195], v[152:155], v[32:35]
    ds_read_b64_tr_b16 v[190:191], v214 offset:3072
    v_mfma_f32_16x16x32_bf16 v[56:59], v[192:195], v[156:159], v[56:59]
    ds_read_b128 v[168:171], v209 offset:0
    v_mfma_f32_16x16x32_bf16 v[80:83], v[192:195], v[160:163], v[80:83]
    ds_read_b128 v[172:175], v209 offset:2048
    v_mfma_f32_16x16x32_bf16 v[104:107], v[192:195], v[164:167], v[104:107]
    ds_read_b128 v[176:179], v209 offset:4096
    v_mfma_f32_16x16x32_bf16 v[128:131], v[192:195], v[204:207], v[128:131]
    s_waitcnt lgkmcnt(7)
    v_mfma_f32_16x16x32_bf16 v[12:15], v[196:199], v[148:151], v[12:15]
    ds_read_b64_tr_b16 v[192:193], v215 offset:0
    v_mfma_f32_16x16x32_bf16 v[36:39], v[196:199], v[152:155], v[36:39]
    ds_read_b64_tr_b16 v[194:195], v215 offset:3072
    v_mfma_f32_16x16x32_bf16 v[60:63], v[196:199], v[156:159], v[60:63]
    ds_read_b128 v[180:183], v209 offset:6144
    v_mfma_f32_16x16x32_bf16 v[84:87], v[196:199], v[160:163], v[84:87]
    ds_read_b128 v[184:187], v209 offset:8192
    v_mfma_f32_16x16x32_bf16 v[108:111], v[196:199], v[164:167], v[108:111]
    s_waitcnt lgkmcnt(9)
    v_mfma_f32_16x16x32_bf16 v[16:19], v[200:203], v[148:151], v[16:19]
    ds_read_b64_tr_b16 v[196:197], v210 offset:12288
    v_mfma_f32_16x16x32_bf16 v[40:43], v[200:203], v[152:155], v[40:43]
    ds_read_b64_tr_b16 v[198:199], v210 offset:15360
    v_add_u32 v208, s62, v208
    v_add_u32 v209, s62, v209
    v_mfma_f32_16x16x32_bf16 v[64:67], v[200:203], v[156:159], v[64:67]
    v_mfma_f32_16x16x32_bf16 v[88:91], v[200:203], v[160:163], v[88:91]
    v_mfma_f32_16x16x32_bf16 v[112:115], v[200:203], v[164:167], v[112:115]
    v_mfma_f32_16x16x32_bf16 v[132:135], v[200:203], v[204:207], v[132:135]
    s_waitcnt lgkmcnt(9)
    v_mfma_f32_16x16x32_bf16 v[20:23], v[188:191], v[148:151], v[20:23]
    ds_read_b64_tr_b16 v[200:201], v211 offset:12288
    v_mfma_f32_16x16x32_bf16 v[44:47], v[188:191], v[152:155], v[44:47]
    ds_read_b64_tr_b16 v[202:203], v211 offset:15360
    v_add_u32 v210, s62, v210
    v_mfma_f32_16x16x32_bf16 v[68:71], v[188:191], v[156:159], v[68:71]
    v_mfma_f32_16x16x32_bf16 v[92:95], v[188:191], v[160:163], v[92:95]
    v_mfma_f32_16x16x32_bf16 v[116:119], v[188:191], v[164:167], v[116:119]
    s_waitcnt lgkmcnt(6)
    v_mfma_f32_16x16x32_bf16 v[24:27], v[192:195], v[148:151], v[24:27]
    ds_read_b64_tr_b16 v[188:189], v212 offset:12288
    v_mfma_f32_16x16x32_bf16 v[48:51], v[192:195], v[152:155], v[48:51]
    ds_read_b64_tr_b16 v[190:191], v212 offset:15360
    v_add_u32 v211, s62, v211
    v_mfma_f32_16x16x32_bf16 v[72:75], v[192:195], v[156:159], v[72:75]
    v_mfma_f32_16x16x32_bf16 v[96:99], v[192:195], v[160:163], v[96:99]
    v_mfma_f32_16x16x32_bf16 v[120:123], v[192:195], v[164:167], v[120:123]
    s_waitcnt lgkmcnt(4)
    v_mfma_f32_16x16x32_bf16 v[4:7], v[196:199], v[168:171], v[4:7]
    ds_read_b64_tr_b16 v[192:193], v213 offset:12288
    v_mfma_f32_16x16x32_bf16 v[28:31], v[196:199], v[172:175], v[28:31]
    ds_read_b64_tr_b16 v[194:195], v213 offset:15360
    v_add_u32 v212, s62, v212
    v_mfma_f32_16x16x32_bf16 v[52:55], v[196:199], v[176:179], v[52:55]
    v_mfma_f32_16x16x32_bf16 v[76:79], v[196:199], v[180:183], v[76:79]
    v_mfma_f32_16x16x32_bf16 v[100:103], v[196:199], v[184:187], v[100:103]
    v_mfma_f32_16x16x32_bf16 v[124:127], v[196:199], v[204:207], v[124:127]
    s_waitcnt lgkmcnt(4)
    v_mfma_f32_16x16x32_bf16 v[8:11], v[200:203], v[168:171], v[8:11]
    ds_read_b64_tr_b16 v[196:197], v214 offset:12288
    v_mfma_f32_16x16x32_bf16 v[32:35], v[200:203], v[172:175], v[32:35]
    ds_read_b64_tr_b16 v[198:199], v214 offset:15360
    v_add_u32 v213, s62, v213
    v_mfma_f32_16x16x32_bf16 v[56:59], v[200:203], v[176:179], v[56:59]
    v_mfma_f32_16x16x32_bf16 v[80:83], v[200:203], v[180:183], v[80:83]
    v_mfma_f32_16x16x32_bf16 v[104:107], v[200:203], v[184:187], v[104:107]
    v_mfma_f32_16x16x32_bf16 v[128:131], v[200:203], v[204:207], v[128:131]
    s_waitcnt lgkmcnt(4)
    v_mfma_f32_16x16x32_bf16 v[12:15], v[188:191], v[168:171], v[12:15]
    ds_read_b64_tr_b16 v[200:201], v215 offset:12288
    v_mfma_f32_16x16x32_bf16 v[36:39], v[188:191], v[172:175], v[36:39]
    ds_read_b64_tr_b16 v[202:203], v215 offset:15360
    v_add_u32 v214, s62, v214
    v_mfma_f32_16x16x32_bf16 v[60:63], v[188:191], v[176:179], v[60:63]
    v_mfma_f32_16x16x32_bf16 v[84:87], v[188:191], v[180:183], v[84:87]
    v_mfma_f32_16x16x32_bf16 v[108:111], v[188:191], v[184:187], v[108:111]
    s_waitcnt lgkmcnt(4)
    v_mfma_f32_16x16x32_bf16 v[16:19], v[192:195], v[168:171], v[16:19]
    v_add_u32 v215, s62, v215
    v_mfma_f32_16x16x32_bf16 v[40:43], v[192:195], v[172:175], v[40:43]
    v_mfma_f32_16x16x32_bf16 v[64:67], v[192:195], v[176:179], v[64:67]
    v_mfma_f32_16x16x32_bf16 v[88:91], v[192:195], v[180:183], v[88:91]
    v_mfma_f32_16x16x32_bf16 v[112:115], v[192:195], v[184:187], v[112:115]
    v_mfma_f32_16x16x32_bf16 v[132:135], v[192:195], v[204:207], v[132:135]
    s_waitcnt lgkmcnt(0)
    s_barrier
    v_mfma_f32_16x16x32_bf16 v[20:23], v[196:199], v[168:171], v[20:23]
    ds_read_b128 v[148:151], v208 offset:0
    ds_read_b128 v[152:155], v208 offset:2048
    v_mfma_f32_16x16x32_bf16 v[44:47], v[196:199], v[172:175], v[44:47]
    ds_read_b128 v[156:159], v208 offset:4096
    ds_read_b128 v[160:163], v208 offset:6144
    v_mfma_f32_16x16x32_bf16 v[68:71], v[196:199], v[176:179], v[68:71]
    ds_read_b128 v[164:167], v208 offset:8192
    ds_read_b64_tr_b16 v[188:189], v210 offset:0
    v_mfma_f32_16x16x32_bf16 v[92:95], v[196:199], v[180:183], v[92:95]
    ds_read_b64_tr_b16 v[190:191], v210 offset:3072
    ds_read_b64_tr_b16 v[192:193], v211 offset:0
    v_mfma_f32_16x16x32_bf16 v[116:119], v[196:199], v[184:187], v[116:119]
    ds_read_b64_tr_b16 v[194:195], v211 offset:3072
    v_mfma_f32_16x16x32_bf16 v[24:27], v[200:203], v[168:171], v[24:27]
    ds_read_b64_tr_b16 v[196:197], v212 offset:0
    v_mfma_f32_16x16x32_bf16 v[48:51], v[200:203], v[172:175], v[48:51]
    ds_read_b64_tr_b16 v[198:199], v212 offset:3072
    v_mfma_f32_16x16x32_bf16 v[72:75], v[200:203], v[176:179], v[72:75]
    v_mfma_f32_16x16x32_bf16 v[96:99], v[200:203], v[180:183], v[96:99]
    v_mfma_f32_16x16x32_bf16 v[120:123], v[200:203], v[184:187], v[120:123]
    s_add_u32 s70, s70, 1
    s_cmp_lt_u32 s70, 10
    s_cbranch_scc1 cB_loop1_57
cB_done_55:
    s_waitcnt lgkmcnt(0)
    s_nop 7
    v_lshlrev_b32 v233, 3, v228
    s_lshl_b32 s51, s42, 5
    s_add_u32 s51, s51, 135168
    v_add_u32 v232, s51, v233
    ds_read_b64 v[216:217], v232
    s_lshl_b32 s51, s43, 5
    s_add_u32 s51, s51, 135168
    v_add_u32 v232, s51, v233
    ds_read_b64 v[218:219], v232
    s_lshl_b32 s51, s44, 5
    s_add_u32 s51, s51, 135168
    v_add_u32 v232, s51, v233
    ds_read_b64 v[220:221], v232
    s_lshl_b32 s51, s45, 5
    s_add_u32 s51, s51, 135168
    v_add_u32 v232, s51, v233
    ds_read_b64 v[222:223], v232
    s_lshl_b32 s51, s46, 5
    s_add_u32 s51, s51, 135168
    v_add_u32 v232, s51, v233
    ds_read_b64 v[224:225], v232
    s_lshl_b32 s51, s47, 5
    s_add_u32 s51, s51, 135168
    v_add_u32 v232, s51, v233
    ds_read_b64 v[226:227], v232
    v_lshlrev_b32 v230, 4, v228
    v_add_u32 v230, 0xe900, v230
    s_lshl_b32 s50, s42, 6
    v_add_u32 v148, s50, v230
    s_lshl_b32 s50, s43, 6
    v_add_u32 v149, s50, v230
    s_lshl_b32 s50, s44, 6
    v_add_u32 v150, s50, v230
    s_lshl_b32 s50, s45, 6
    v_add_u32 v151, s50, v230
    s_lshl_b32 s50, s46, 6
    v_add_u32 v152, s50, v230
    s_lshl_b32 s50, s47, 6
    v_add_u32 v153, s50, v230
    s_mul_i32 s50, s40, 320
    v_lshlrev_b32 v232, 2, v229
    v_add_u32 v232, s50, v232
    v_add_u32 v232, 0xe400, v232
    s_mov_b32 exec_lo, 0x00010001
    s_mov_b32 exec_hi, 0x00010001
    ds_write_b128 v148, v[124:127]
    ds_write_b128 v149, v[128:131]
    s_cmp_lg_u32 s40, 0
    s_cbranch_scc1 cB_cs3_58
    ds_write_b128 v150, v[132:135]
    s_branch cB_csd_59
cB_cs3_58:
    ds_write_b128 v151, v[132:135]
cB_csd_59:
    s_mov_b64 exec, -1
    s_waitcnt lgkmcnt(0)
    s_barrier
    v_mov_b32 v233, 0xecc0
    ds_read_b32 v233, v233
    ds_read_b32 v154, v232 offset:0
    ds_read_b32 v155, v232 offset:640
    ds_read_b32 v156, v232 offset:64
    ds_read_b32 v157, v232 offset:704
    ds_read_b32 v158, v232 offset:128
    ds_read_b32 v159, v232 offset:768
    ds_read_b32 v160, v232 offset:192
    ds_read_b32 v161, v232 offset:832
    ds_read_b32 v162, v232 offset:256
    ds_read_b32 v163, v232 offset:896
    ds_read_b128 v[132:135], v150
    ds_read_b128 v[136:139], v151
    ds_read_b128 v[140:143], v152
    ds_read_b128 v[144:147], v153
    v_lshlrev_b32 v164, 16, v216
    v_and_b32 v165, 0xffff0000, v216
    v_lshlrev_b32 v166, 16, v217
    v_and_b32 v167, 0xffff0000, v217
    v_lshlrev_b32 v168, 16, v218
    v_and_b32 v169, 0xffff0000, v218
    v_lshlrev_b32 v170, 16, v219
    v_and_b32 v171, 0xffff0000, v219
    v_lshlrev_b32 v172, 16, v220
    v_and_b32 v173, 0xffff0000, v220
    v_lshlrev_b32 v174, 16, v221
    v_and_b32 v175, 0xffff0000, v221
    v_lshlrev_b32 v176, 16, v222
    v_and_b32 v177, 0xffff0000, v222
    v_lshlrev_b32 v178, 16, v223
    v_and_b32 v179, 0xffff0000, v223
    v_lshlrev_b32 v180, 16, v224
    v_and_b32 v181, 0xffff0000, v224
    v_lshlrev_b32 v182, 16, v225
    v_and_b32 v183, 0xffff0000, v225
    v_lshlrev_b32 v184, 16, v226
    v_and_b32 v185, 0xffff0000, v226
    v_lshlrev_b32 v186, 16, v227
    v_and_b32 v187, 0xffff0000, v227
    v_lshlrev_b32 v188, 4, v0
    s_mul_i32 s50, s34, 6
    s_add_u32 s50, s50, 20
    s_lshr_b32 s51, s42, 1
    s_add_u32 s51, s51, s50
    s_lshl_b32 s60, s51, 12
    s_lshr_b32 s51, s44, 1
    s_add_u32 s51, s51, s50
    s_lshl_b32 s61, s51, 12
    s_lshr_b32 s51, s46, 1
    s_add_u32 s51, s51, s50
    s_lshl_b32 s62, s51, 12
    s_waitcnt lgkmcnt(0)
    v_readfirstlane_b32 s73, v233
    s_mul_i32 s54, s33, 10
    s_mul_i32 s55, s40, 5
    s_add_u32 s54, s54, s55
    s_add_u32 s54, s54, 0
    s_cmp_ge_u32 s54, 128
    s_cbranch_scc1 cB_pub
    s_lshr_b32 s55, s54, 2
    s_mul_i32 s55, s55, 278528
    s_and_b32 s54, s54, 3
    s_lshl_b32 s54, s54, 10
    s_add_u32 s54, s54, s55
    v_pk_fma_f32 v[4:5], v[124:125], v[154:155], v[4:5] op_sel:[0,1,0] op_sel_hi:[1,1,1]
    v_pk_fma_f32 v[6:7], v[126:127], v[154:155], v[6:7] op_sel:[0,1,0] op_sel_hi:[1,1,1]
    v_pk_fma_f32 v[4:5], v[4:5], v[154:155], v[164:165] op_sel_hi:[1,0,1]
    v_pk_fma_f32 v[6:7], v[6:7], v[154:155], v[166:167] op_sel_hi:[1,0,1]
    v_max_f32 v4, 0, v4
    v_max_f32 v5, 0, v5
    v_max_f32 v6, 0, v6
    v_max_f32 v7, 0, v7
    v_pk_mul_f32 v[4:5], v[4:5], v[4:5]
    v_pk_mul_f32 v[6:7], v[6:7], v[6:7]
    v_cvt_pk_bf16_f32 v4, v4, v5
    v_cvt_pk_bf16_f32 v5, v6, v7
    v_pk_fma_f32 v[8:9], v[128:129], v[154:155], v[8:9] op_sel:[0,1,0] op_sel_hi:[1,1,1]
    v_pk_fma_f32 v[10:11], v[130:131], v[154:155], v[10:11] op_sel:[0,1,0] op_sel_hi:[1,1,1]
    v_pk_fma_f32 v[8:9], v[8:9], v[154:155], v[168:169] op_sel_hi:[1,0,1]
    v_pk_fma_f32 v[10:11], v[10:11], v[154:155], v[170:171] op_sel_hi:[1,0,1]
    v_max_f32 v8, 0, v8
    v_max_f32 v9, 0, v9
    v_max_f32 v10, 0, v10
    v_max_f32 v11, 0, v11
    v_pk_mul_f32 v[8:9], v[8:9], v[8:9]
    v_pk_mul_f32 v[10:11], v[10:11], v[10:11]
    v_cvt_pk_bf16_f32 v6, v8, v9
    v_cvt_pk_bf16_f32 v7, v10, v11
    s_add_u32 s56, s54, s60
    buffer_store_dwordx4 v[4:7], v188, s[24:27], s56 offen sc1
    v_pk_fma_f32 v[12:13], v[132:133], v[154:155], v[12:13] op_sel:[0,1,0] op_sel_hi:[1,1,1]
    v_pk_fma_f32 v[14:15], v[134:135], v[154:155], v[14:15] op_sel:[0,1,0] op_sel_hi:[1,1,1]
    v_pk_fma_f32 v[12:13], v[12:13], v[154:155], v[172:173] op_sel_hi:[1,0,1]
    v_pk_fma_f32 v[14:15], v[14:15], v[154:155], v[174:175] op_sel_hi:[1,0,1]
    v_max_f32 v12, 0, v12
    v_max_f32 v13, 0, v13
    v_max_f32 v14, 0, v14
    v_max_f32 v15, 0, v15
    v_pk_mul_f32 v[12:13], v[12:13], v[12:13]
    v_pk_mul_f32 v[14:15], v[14:15], v[14:15]
    v_cvt_pk_bf16_f32 v12, v12, v13
    v_cvt_pk_bf16_f32 v13, v14, v15
    v_pk_fma_f32 v[16:17], v[136:137], v[154:155], v[16:17] op_sel:[0,1,0] op_sel_hi:[1,1,1]
    v_pk_fma_f32 v[18:19], v[138:139], v[154:155], v[18:19] op_sel:[0,1,0] op_sel_hi:[1,1,1]
    v_pk_fma_f32 v[16:17], v[16:17], v[154:155], v[176:177] op_sel_hi:[1,0,1]
    v_pk_fma_f32 v[18:19], v[18:19], v[154:155], v[178:179] op_sel_hi:[1,0,1]
    v_max_f32 v16, 0, v16
    v_max_f32 v17, 0, v17
    v_max_f32 v18, 0, v18
    v_max_f32 v19, 0, v19
    v_pk_mul_f32 v[16:17], v[16:17], v[16:17]
    v_pk_mul_f32 v[18:19], v[18:19], v[18:19]
    v_cvt_pk_bf16_f32 v14, v16, v17
    v_cvt_pk_bf16_f32 v15, v18, v19
    s_add_u32 s56, s54, s61
    buffer_store_dwordx4 v[12:15], v188, s[24:27], s56 offen sc1
    v_pk_fma_f32 v[20:21], v[140:141], v[154:155], v[20:21] op_sel:[0,1,0] op_sel_hi:[1,1,1]
    v_pk_fma_f32 v[22:23], v[142:143], v[154:155], v[22:23] op_sel:[0,1,0] op_sel_hi:[1,1,1]
    v_pk_fma_f32 v[20:21], v[20:21], v[154:155], v[180:181] op_sel_hi:[1,0,1]
    v_pk_fma_f32 v[22:23], v[22:23], v[154:155], v[182:183] op_sel_hi:[1,0,1]
    v_max_f32 v20, 0, v20
    v_max_f32 v21, 0, v21
    v_max_f32 v22, 0, v22
    v_max_f32 v23, 0, v23
    v_pk_mul_f32 v[20:21], v[20:21], v[20:21]
    v_pk_mul_f32 v[22:23], v[22:23], v[22:23]
    v_cvt_pk_bf16_f32 v20, v20, v21
    v_cvt_pk_bf16_f32 v21, v22, v23
    v_pk_fma_f32 v[24:25], v[144:145], v[154:155], v[24:25] op_sel:[0,1,0] op_sel_hi:[1,1,1]
    v_pk_fma_f32 v[26:27], v[146:147], v[154:155], v[26:27] op_sel:[0,1,0] op_sel_hi:[1,1,1]
    v_pk_fma_f32 v[24:25], v[24:25], v[154:155], v[184:185] op_sel_hi:[1,0,1]
    v_pk_fma_f32 v[26:27], v[26:27], v[154:155], v[186:187] op_sel_hi:[1,0,1]
    v_max_f32 v24, 0, v24
    v_max_f32 v25, 0, v25
    v_max_f32 v26, 0, v26
    v_max_f32 v27, 0, v27
    v_pk_mul_f32 v[24:25], v[24:25], v[24:25]
    v_pk_mul_f32 v[26:27], v[26:27], v[26:27]
    v_cvt_pk_bf16_f32 v22, v24, v25
    v_cvt_pk_bf16_f32 v23, v26, v27
    s_add_u32 s56, s54, s62
    buffer_store_dwordx4 v[20:23], v188, s[24:27], s56 offen sc1
    s_mul_i32 s54, s33, 10
    s_mul_i32 s55, s40, 5
    s_add_u32 s54, s54, s55
    s_add_u32 s54, s54, 1
    s_cmp_ge_u32 s54, 128
    s_cbranch_scc1 cB_pub
    s_lshr_b32 s55, s54, 2
    s_mul_i32 s55, s55, 278528
    s_and_b32 s54, s54, 3
    s_lshl_b32 s54, s54, 10
    s_add_u32 s54, s54, s55
    v_pk_fma_f32 v[28:29], v[124:125], v[156:157], v[28:29] op_sel:[0,1,0] op_sel_hi:[1,1,1]
    v_pk_fma_f32 v[30:31], v[126:127], v[156:157], v[30:31] op_sel:[0,1,0] op_sel_hi:[1,1,1]
    v_pk_fma_f32 v[28:29], v[28:29], v[156:157], v[164:165] op_sel_hi:[1,0,1]
    v_pk_fma_f32 v[30:31], v[30:31], v[156:157], v[166:167] op_sel_hi:[1,0,1]
    v_max_f32 v28, 0, v28
    v_max_f32 v29, 0, v29
    v_max_f32 v30, 0, v30
    v_max_f32 v31, 0, v31
    v_pk_mul_f32 v[28:29], v[28:29], v[28:29]
    v_pk_mul_f32 v[30:31], v[30:31], v[30:31]
    v_cvt_pk_bf16_f32 v28, v28, v29
    v_cvt_pk_bf16_f32 v29, v30, v31
    v_pk_fma_f32 v[32:33], v[128:129], v[156:157], v[32:33] op_sel:[0,1,0] op_sel_hi:[1,1,1]
    v_pk_fma_f32 v[34:35], v[130:131], v[156:157], v[34:35] op_sel:[0,1,0] op_sel_hi:[1,1,1]
    v_pk_fma_f32 v[32:33], v[32:33], v[156:157], v[168:169] op_sel_hi:[1,0,1]
    v_pk_fma_f32 v[34:35], v[34:35], v[156:157], v[170:171] op_sel_hi:[1,0,1]
    v_max_f32 v32, 0, v32
    v_max_f32 v33, 0, v33
    v_max_f32 v34, 0, v34
    v_max_f32 v35, 0, v35
    v_pk_mul_f32 v[32:33], v[32:33], v[32:33]
    v_pk_mul_f32 v[34:35], v[34:35], v[34:35]
    v_cvt_pk_bf16_f32 v30, v32, v33
    v_cvt_pk_bf16_f32 v31, v34, v35
    s_add_u32 s56, s54, s60
    buffer_store_dwordx4 v[28:31], v188, s[24:27], s56 offen sc1
    v_pk_fma_f32 v[36:37], v[132:133], v[156:157], v[36:37] op_sel:[0,1,0] op_sel_hi:[1,1,1]
    v_pk_fma_f32 v[38:39], v[134:135], v[156:157], v[38:39] op_sel:[0,1,0] op_sel_hi:[1,1,1]
    v_pk_fma_f32 v[36:37], v[36:37], v[156:157], v[172:173] op_sel_hi:[1,0,1]
    v_pk_fma_f32 v[38:39], v[38:39], v[156:157], v[174:175] op_sel_hi:[1,0,1]
    v_max_f32 v36, 0, v36
    v_max_f32 v37, 0, v37
    v_max_f32 v38, 0, v38
    v_max_f32 v39, 0, v39
    v_pk_mul_f32 v[36:37], v[36:37], v[36:37]
    v_pk_mul_f32 v[38:39], v[38:39], v[38:39]
    v_cvt_pk_bf16_f32 v36, v36, v37
    v_cvt_pk_bf16_f32 v37, v38, v39
    v_pk_fma_f32 v[40:41], v[136:137], v[156:157], v[40:41] op_sel:[0,1,0] op_sel_hi:[1,1,1]
    v_pk_fma_f32 v[42:43], v[138:139], v[156:157], v[42:43] op_sel:[0,1,0] op_sel_hi:[1,1,1]
    v_pk_fma_f32 v[40:41], v[40:41], v[156:157], v[176:177] op_sel_hi:[1,0,1]
    v_pk_fma_f32 v[42:43], v[42:43], v[156:157], v[178:179] op_sel_hi:[1,0,1]
    v_max_f32 v40, 0, v40
    v_max_f32 v41, 0, v41
    v_max_f32 v42, 0, v42
    v_max_f32 v43, 0, v43
    v_pk_mul_f32 v[40:41], v[40:41], v[40:41]
    v_pk_mul_f32 v[42:43], v[42:43], v[42:43]
    v_cvt_pk_bf16_f32 v38, v40, v41
    v_cvt_pk_bf16_f32 v39, v42, v43
    s_add_u32 s56, s54, s61
    buffer_store_dwordx4 v[36:39], v188, s[24:27], s56 offen sc1
    v_pk_fma_f32 v[44:45], v[140:141], v[156:157], v[44:45] op_sel:[0,1,0] op_sel_hi:[1,1,1]
    v_pk_fma_f32 v[46:47], v[142:143], v[156:157], v[46:47] op_sel:[0,1,0] op_sel_hi:[1,1,1]
    v_pk_fma_f32 v[44:45], v[44:45], v[156:157], v[180:181] op_sel_hi:[1,0,1]
    v_pk_fma_f32 v[46:47], v[46:47], v[156:157], v[182:183] op_sel_hi:[1,0,1]
    v_max_f32 v44, 0, v44
    v_max_f32 v45, 0, v45
    v_max_f32 v46, 0, v46
    v_max_f32 v47, 0, v47
    v_pk_mul_f32 v[44:45], v[44:45], v[44:45]
    v_pk_mul_f32 v[46:47], v[46:47], v[46:47]
    v_cvt_pk_bf16_f32 v44, v44, v45
    v_cvt_pk_bf16_f32 v45, v46, v47
    v_pk_fma_f32 v[48:49], v[144:145], v[156:157], v[48:49] op_sel:[0,1,0] op_sel_hi:[1,1,1]
    v_pk_fma_f32 v[50:51], v[146:147], v[156:157], v[50:51] op_sel:[0,1,0] op_sel_hi:[1,1,1]
    v_pk_fma_f32 v[48:49], v[48:49], v[156:157], v[184:185] op_sel_hi:[1,0,1]
    v_pk_fma_f32 v[50:51], v[50:51], v[156:157], v[186:187] op_sel_hi:[1,0,1]
    v_max_f32 v48, 0, v48
    v_max_f32 v49, 0, v49
    v_max_f32 v50, 0, v50
    v_max_f32 v51, 0, v51
    v_pk_mul_f32 v[48:49], v[48:49], v[48:49]
    v_pk_mul_f32 v[50:51], v[50:51], v[50:51]
    v_cvt_pk_bf16_f32 v46, v48, v49
    v_cvt_pk_bf16_f32 v47, v50, v51
    s_add_u32 s56, s54, s62
    buffer_store_dwordx4 v[44:47], v188, s[24:27], s56 offen sc1
    s_mul_i32 s54, s33, 10
    s_mul_i32 s55, s40, 5
    s_add_u32 s54, s54, s55
    s_add_u32 s54, s54, 2
    s_cmp_ge_u32 s54, 128
    s_cbranch_scc1 cB_pub
    s_lshr_b32 s55, s54, 2
    s_mul_i32 s55, s55, 278528
    s_and_b32 s54, s54, 3
    s_lshl_b32 s54, s54, 10
    s_add_u32 s54, s54, s55
    v_pk_fma_f32 v[52:53], v[124:125], v[158:159], v[52:53] op_sel:[0,1,0] op_sel_hi:[1,1,1]
    v_pk_fma_f32 v[54:55], v[126:127], v[158:159], v[54:55] op_sel:[0,1,0] op_sel_hi:[1,1,1]
    v_pk_fma_f32 v[52:53], v[52:53], v[158:159], v[164:165] op_sel_hi:[1,0,1]
    v_pk_fma_f32 v[54:55], v[54:55], v[158:159], v[166:167] op_sel_hi:[1,0,1]
    v_max_f32 v52, 0, v52
    v_max_f32 v53, 0, v53
    v_max_f32 v54, 0, v54
    v_max_f32 v55, 0, v55
    v_pk_mul_f32 v[52:53], v[52:53], v[52:53]
    v_pk_mul_f32 v[54:55], v[54:55], v[54:55]
    v_cvt_pk_bf16_f32 v52, v52, v53
    v_cvt_pk_bf16_f32 v53, v54, v55
    v_pk_fma_f32 v[56:57], v[128:129], v[158:159], v[56:57] op_sel:[0,1,0] op_sel_hi:[1,1,1]
    v_pk_fma_f32 v[58:59], v[130:131], v[158:159], v[58:59] op_sel:[0,1,0] op_sel_hi:[1,1,1]
    v_pk_fma_f32 v[56:57], v[56:57], v[158:159], v[168:169] op_sel_hi:[1,0,1]
    v_pk_fma_f32 v[58:59], v[58:59], v[158:159], v[170:171] op_sel_hi:[1,0,1]
    v_max_f32 v56, 0, v56
    v_max_f32 v57, 0, v57
    v_max_f32 v58, 0, v58
    v_max_f32 v59, 0, v59
    v_pk_mul_f32 v[56:57], v[56:57], v[56:57]
    v_pk_mul_f32 v[58:59], v[58:59], v[58:59]
    v_cvt_pk_bf16_f32 v54, v56, v57
    v_cvt_pk_bf16_f32 v55, v58, v59
    s_add_u32 s56, s54, s60
    buffer_store_dwordx4 v[52:55], v188, s[24:27], s56 offen sc1
    v_pk_fma_f32 v[60:61], v[132:133], v[158:159], v[60:61] op_sel:[0,1,0] op_sel_hi:[1,1,1]
    v_pk_fma_f32 v[62:63], v[134:135], v[158:159], v[62:63] op_sel:[0,1,0] op_sel_hi:[1,1,1]
    v_pk_fma_f32 v[60:61], v[60:61], v[158:159], v[172:173] op_sel_hi:[1,0,1]
    v_pk_fma_f32 v[62:63], v[62:63], v[158:159], v[174:175] op_sel_hi:[1,0,1]
    v_max_f32 v60, 0, v60
    v_max_f32 v61, 0, v61
    v_max_f32 v62, 0, v62
    v_max_f32 v63, 0, v63
    v_pk_mul_f32 v[60:61], v[60:61], v[60:61]
    v_pk_mul_f32 v[62:63], v[62:63], v[62:63]
    v_cvt_pk_bf16_f32 v60, v60, v61
    v_cvt_pk_bf16_f32 v61, v62, v63
    v_pk_fma_f32 v[64:65], v[136:137], v[158:159], v[64:65] op_sel:[0,1,0] op_sel_hi:[1,1,1]
    v_pk_fma_f32 v[66:67], v[138:139], v[158:159], v[66:67] op_sel:[0,1,0] op_sel_hi:[1,1,1]
    v_pk_fma_f32 v[64:65], v[64:65], v[158:159], v[176:177] op_sel_hi:[1,0,1]
    v_pk_fma_f32 v[66:67], v[66:67], v[158:159], v[178:179] op_sel_hi:[1,0,1]
    v_max_f32 v64, 0, v64
    v_max_f32 v65, 0, v65
    v_max_f32 v66, 0, v66
    v_max_f32 v67, 0, v67
    v_pk_mul_f32 v[64:65], v[64:65], v[64:65]
    v_pk_mul_f32 v[66:67], v[66:67], v[66:67]
    v_cvt_pk_bf16_f32 v62, v64, v65
    v_cvt_pk_bf16_f32 v63, v66, v67
    s_add_u32 s56, s54, s61
    buffer_store_dwordx4 v[60:63], v188, s[24:27], s56 offen sc1
    v_pk_fma_f32 v[68:69], v[140:141], v[158:159], v[68:69] op_sel:[0,1,0] op_sel_hi:[1,1,1]
    v_pk_fma_f32 v[70:71], v[142:143], v[158:159], v[70:71] op_sel:[0,1,0] op_sel_hi:[1,1,1]
    v_pk_fma_f32 v[68:69], v[68:69], v[158:159], v[180:181] op_sel_hi:[1,0,1]
    v_pk_fma_f32 v[70:71], v[70:71], v[158:159], v[182:183] op_sel_hi:[1,0,1]
    v_max_f32 v68, 0, v68
    v_max_f32 v69, 0, v69
    v_max_f32 v70, 0, v70
    v_max_f32 v71, 0, v71
    v_pk_mul_f32 v[68:69], v[68:69], v[68:69]
    v_pk_mul_f32 v[70:71], v[70:71], v[70:71]
    v_cvt_pk_bf16_f32 v68, v68, v69
    v_cvt_pk_bf16_f32 v69, v70, v71
    v_pk_fma_f32 v[72:73], v[144:145], v[158:159], v[72:73] op_sel:[0,1,0] op_sel_hi:[1,1,1]
    v_pk_fma_f32 v[74:75], v[146:147], v[158:159], v[74:75] op_sel:[0,1,0] op_sel_hi:[1,1,1]
    v_pk_fma_f32 v[72:73], v[72:73], v[158:159], v[184:185] op_sel_hi:[1,0,1]
    v_pk_fma_f32 v[74:75], v[74:75], v[158:159], v[186:187] op_sel_hi:[1,0,1]
    v_max_f32 v72, 0, v72
    v_max_f32 v73, 0, v73
    v_max_f32 v74, 0, v74
    v_max_f32 v75, 0, v75
    v_pk_mul_f32 v[72:73], v[72:73], v[72:73]
    v_pk_mul_f32 v[74:75], v[74:75], v[74:75]
    v_cvt_pk_bf16_f32 v70, v72, v73
    v_cvt_pk_bf16_f32 v71, v74, v75
    s_add_u32 s56, s54, s62
    buffer_store_dwordx4 v[68:71], v188, s[24:27], s56 offen sc1
    s_mul_i32 s54, s33, 10
    s_mul_i32 s55, s40, 5
    s_add_u32 s54, s54, s55
    s_add_u32 s54, s54, 3
    s_cmp_ge_u32 s54, 128
    s_cbranch_scc1 cB_pub
    s_lshr_b32 s55, s54, 2
    s_mul_i32 s55, s55, 278528
    s_and_b32 s54, s54, 3
    s_lshl_b32 s54, s54, 10
    s_add_u32 s54, s54, s55
    v_pk_fma_f32 v[76:77], v[124:125], v[160:161], v[76:77] op_sel:[0,1,0] op_sel_hi:[1,1,1]
    v_pk_fma_f32 v[78:79], v[126:127], v[160:161], v[78:79] op_sel:[0,1,0] op_sel_hi:[1,1,1]
    v_pk_fma_f32 v[76:77], v[76:77], v[160:161], v[164:165] op_sel_hi:[1,0,1]
    v_pk_fma_f32 v[78:79], v[78:79], v[160:161], v[166:167] op_sel_hi:[1,0,1]
    v_max_f32 v76, 0, v76
    v_max_f32 v77, 0, v77
    v_max_f32 v78, 0, v78
    v_max_f32 v79, 0, v79
    v_pk_mul_f32 v[76:77], v[76:77], v[76:77]
    v_pk_mul_f32 v[78:79], v[78:79], v[78:79]
    v_cvt_pk_bf16_f32 v76, v76, v77
    v_cvt_pk_bf16_f32 v77, v78, v79
    v_pk_fma_f32 v[80:81], v[128:129], v[160:161], v[80:81] op_sel:[0,1,0] op_sel_hi:[1,1,1]
    v_pk_fma_f32 v[82:83], v[130:131], v[160:161], v[82:83] op_sel:[0,1,0] op_sel_hi:[1,1,1]
    v_pk_fma_f32 v[80:81], v[80:81], v[160:161], v[168:169] op_sel_hi:[1,0,1]
    v_pk_fma_f32 v[82:83], v[82:83], v[160:161], v[170:171] op_sel_hi:[1,0,1]
    v_max_f32 v80, 0, v80
    v_max_f32 v81, 0, v81
    v_max_f32 v82, 0, v82
    v_max_f32 v83, 0, v83
    v_pk_mul_f32 v[80:81], v[80:81], v[80:81]
    v_pk_mul_f32 v[82:83], v[82:83], v[82:83]
    v_cvt_pk_bf16_f32 v78, v80, v81
    v_cvt_pk_bf16_f32 v79, v82, v83
    s_add_u32 s56, s54, s60
    buffer_store_dwordx4 v[76:79], v188, s[24:27], s56 offen sc1
    v_pk_fma_f32 v[84:85], v[132:133], v[160:161], v[84:85] op_sel:[0,1,0] op_sel_hi:[1,1,1]
    v_pk_fma_f32 v[86:87], v[134:135], v[160:161], v[86:87] op_sel:[0,1,0] op_sel_hi:[1,1,1]
    v_pk_fma_f32 v[84:85], v[84:85], v[160:161], v[172:173] op_sel_hi:[1,0,1]
    v_pk_fma_f32 v[86:87], v[86:87], v[160:161], v[174:175] op_sel_hi:[1,0,1]
    v_max_f32 v84, 0, v84
    v_max_f32 v85, 0, v85
    v_max_f32 v86, 0, v86
    v_max_f32 v87, 0, v87
    v_pk_mul_f32 v[84:85], v[84:85], v[84:85]
    v_pk_mul_f32 v[86:87], v[86:87], v[86:87]
    v_cvt_pk_bf16_f32 v84, v84, v85
    v_cvt_pk_bf16_f32 v85, v86, v87
    v_pk_fma_f32 v[88:89], v[136:137], v[160:161], v[88:89] op_sel:[0,1,0] op_sel_hi:[1,1,1]
    v_pk_fma_f32 v[90:91], v[138:139], v[160:161], v[90:91] op_sel:[0,1,0] op_sel_hi:[1,1,1]
    v_pk_fma_f32 v[88:89], v[88:89], v[160:161], v[176:177] op_sel_hi:[1,0,1]
    v_pk_fma_f32 v[90:91], v[90:91], v[160:161], v[178:179] op_sel_hi:[1,0,1]
    v_max_f32 v88, 0, v88
    v_max_f32 v89, 0, v89
    v_max_f32 v90, 0, v90
    v_max_f32 v91, 0, v91
    v_pk_mul_f32 v[88:89], v[88:89], v[88:89]
    v_pk_mul_f32 v[90:91], v[90:91], v[90:91]
    v_cvt_pk_bf16_f32 v86, v88, v89
    v_cvt_pk_bf16_f32 v87, v90, v91
    s_add_u32 s56, s54, s61
    buffer_store_dwordx4 v[84:87], v188, s[24:27], s56 offen sc1
    v_pk_fma_f32 v[92:93], v[140:141], v[160:161], v[92:93] op_sel:[0,1,0] op_sel_hi:[1,1,1]
    v_pk_fma_f32 v[94:95], v[142:143], v[160:161], v[94:95] op_sel:[0,1,0] op_sel_hi:[1,1,1]
    v_pk_fma_f32 v[92:93], v[92:93], v[160:161], v[180:181] op_sel_hi:[1,0,1]
    v_pk_fma_f32 v[94:95], v[94:95], v[160:161], v[182:183] op_sel_hi:[1,0,1]
    v_max_f32 v92, 0, v92
    v_max_f32 v93, 0, v93
    v_max_f32 v94, 0, v94
    v_max_f32 v95, 0, v95
    v_pk_mul_f32 v[92:93], v[92:93], v[92:93]
    v_pk_mul_f32 v[94:95], v[94:95], v[94:95]
    v_cvt_pk_bf16_f32 v92, v92, v93
    v_cvt_pk_bf16_f32 v93, v94, v95
    v_pk_fma_f32 v[96:97], v[144:145], v[160:161], v[96:97] op_sel:[0,1,0] op_sel_hi:[1,1,1]
    v_pk_fma_f32 v[98:99], v[146:147], v[160:161], v[98:99] op_sel:[0,1,0] op_sel_hi:[1,1,1]
    v_pk_fma_f32 v[96:97], v[96:97], v[160:161], v[184:185] op_sel_hi:[1,0,1]
    v_pk_fma_f32 v[98:99], v[98:99], v[160:161], v[186:187] op_sel_hi:[1,0,1]
    v_max_f32 v96, 0, v96
    v_max_f32 v97, 0, v97
    v_max_f32 v98, 0, v98
    v_max_f32 v99, 0, v99
    v_pk_mul_f32 v[96:97], v[96:97], v[96:97]
    v_pk_mul_f32 v[98:99], v[98:99], v[98:99]
    v_cvt_pk_bf16_f32 v94, v96, v97
    v_cvt_pk_bf16_f32 v95, v98, v99
    s_add_u32 s56, s54, s62
    buffer_store_dwordx4 v[92:95], v188, s[24:27], s56 offen sc1
    s_mul_i32 s54, s33, 10
    s_mul_i32 s55, s40, 5
    s_add_u32 s54, s54, s55
    s_add_u32 s54, s54, 4
    s_cmp_ge_u32 s54, 128
    s_cbranch_scc1 cB_pub
    s_lshr_b32 s55, s54, 2
    s_mul_i32 s55, s55, 278528
    s_and_b32 s54, s54, 3
    s_lshl_b32 s54, s54, 10
    s_add_u32 s54, s54, s55
    v_pk_fma_f32 v[100:101], v[124:125], v[162:163], v[100:101] op_sel:[0,1,0] op_sel_hi:[1,1,1]
    v_pk_fma_f32 v[102:103], v[126:127], v[162:163], v[102:103] op_sel:[0,1,0] op_sel_hi:[1,1,1]
    v_pk_fma_f32 v[100:101], v[100:101], v[162:163], v[164:165] op_sel_hi:[1,0,1]
    v_pk_fma_f32 v[102:103], v[102:103], v[162:163], v[166:167] op_sel_hi:[1,0,1]
    v_max_f32 v100, 0, v100
    v_max_f32 v101, 0, v101
    v_max_f32 v102, 0, v102
    v_max_f32 v103, 0, v103
    v_pk_mul_f32 v[100:101], v[100:101], v[100:101]
    v_pk_mul_f32 v[102:103], v[102:103], v[102:103]
    v_cvt_pk_bf16_f32 v100, v100, v101
    v_cvt_pk_bf16_f32 v101, v102, v103
    v_pk_fma_f32 v[104:105], v[128:129], v[162:163], v[104:105] op_sel:[0,1,0] op_sel_hi:[1,1,1]
    v_pk_fma_f32 v[106:107], v[130:131], v[162:163], v[106:107] op_sel:[0,1,0] op_sel_hi:[1,1,1]
    v_pk_fma_f32 v[104:105], v[104:105], v[162:163], v[168:169] op_sel_hi:[1,0,1]
    v_pk_fma_f32 v[106:107], v[106:107], v[162:163], v[170:171] op_sel_hi:[1,0,1]
    v_max_f32 v104, 0, v104
    v_max_f32 v105, 0, v105
    v_max_f32 v106, 0, v106
    v_max_f32 v107, 0, v107
    v_pk_mul_f32 v[104:105], v[104:105], v[104:105]
    v_pk_mul_f32 v[106:107], v[106:107], v[106:107]
    v_cvt_pk_bf16_f32 v102, v104, v105
    v_cvt_pk_bf16_f32 v103, v106, v107
    s_add_u32 s56, s54, s60
    buffer_store_dwordx4 v[100:103], v188, s[24:27], s56 offen sc1
    v_pk_fma_f32 v[108:109], v[132:133], v[162:163], v[108:109] op_sel:[0,1,0] op_sel_hi:[1,1,1]
    v_pk_fma_f32 v[110:111], v[134:135], v[162:163], v[110:111] op_sel:[0,1,0] op_sel_hi:[1,1,1]
    v_pk_fma_f32 v[108:109], v[108:109], v[162:163], v[172:173] op_sel_hi:[1,0,1]
    v_pk_fma_f32 v[110:111], v[110:111], v[162:163], v[174:175] op_sel_hi:[1,0,1]
    v_max_f32 v108, 0, v108
    v_max_f32 v109, 0, v109
    v_max_f32 v110, 0, v110
    v_max_f32 v111, 0, v111
    v_pk_mul_f32 v[108:109], v[108:109], v[108:109]
    v_pk_mul_f32 v[110:111], v[110:111], v[110:111]
    v_cvt_pk_bf16_f32 v108, v108, v109
    v_cvt_pk_bf16_f32 v109, v110, v111
    v_pk_fma_f32 v[112:113], v[136:137], v[162:163], v[112:113] op_sel:[0,1,0] op_sel_hi:[1,1,1]
    v_pk_fma_f32 v[114:115], v[138:139], v[162:163], v[114:115] op_sel:[0,1,0] op_sel_hi:[1,1,1]
    v_pk_fma_f32 v[112:113], v[112:113], v[162:163], v[176:177] op_sel_hi:[1,0,1]
    v_pk_fma_f32 v[114:115], v[114:115], v[162:163], v[178:179] op_sel_hi:[1,0,1]
    v_max_f32 v112, 0, v112
    v_max_f32 v113, 0, v113
    v_max_f32 v114, 0, v114
    v_max_f32 v115, 0, v115
    v_pk_mul_f32 v[112:113], v[112:113], v[112:113]
    v_pk_mul_f32 v[114:115], v[114:115], v[114:115]
    v_cvt_pk_bf16_f32 v110, v112, v113
    v_cvt_pk_bf16_f32 v111, v114, v115
    s_add_u32 s56, s54, s61
    buffer_store_dwordx4 v[108:111], v188, s[24:27], s56 offen sc1
    v_pk_fma_f32 v[116:117], v[140:141], v[162:163], v[116:117] op_sel:[0,1,0] op_sel_hi:[1,1,1]
    v_pk_fma_f32 v[118:119], v[142:143], v[162:163], v[118:119] op_sel:[0,1,0] op_sel_hi:[1,1,1]
    v_pk_fma_f32 v[116:117], v[116:117], v[162:163], v[180:181] op_sel_hi:[1,0,1]
    v_pk_fma_f32 v[118:119], v[118:119], v[162:163], v[182:183] op_sel_hi:[1,0,1]
    v_max_f32 v116, 0, v116
    v_max_f32 v117, 0, v117
    v_max_f32 v118, 0, v118
    v_max_f32 v119, 0, v119
    v_pk_mul_f32 v[116:117], v[116:117], v[116:117]
    v_pk_mul_f32 v[118:119], v[118:119], v[118:119]
    v_cvt_pk_bf16_f32 v116, v116, v117
    v_cvt_pk_bf16_f32 v117, v118, v119
    v_pk_fma_f32 v[120:121], v[144:145], v[162:163], v[120:121] op_sel:[0,1,0] op_sel_hi:[1,1,1]
    v_pk_fma_f32 v[122:123], v[146:147], v[162:163], v[122:123] op_sel:[0,1,0] op_sel_hi:[1,1,1]
    v_pk_fma_f32 v[120:121], v[120:121], v[162:163], v[184:185] op_sel_hi:[1,0,1]
    v_pk_fma_f32 v[122:123], v[122:123], v[162:163], v[186:187] op_sel_hi:[1,0,1]
    v_max_f32 v120, 0, v120
    v_max_f32 v121, 0, v121
    v_max_f32 v122, 0, v122
    v_max_f32 v123, 0, v123
    v_pk_mul_f32 v[120:121], v[120:121], v[120:121]
    v_pk_mul_f32 v[122:123], v[122:123], v[122:123]
    v_cvt_pk_bf16_f32 v118, v120, v121
    v_cvt_pk_bf16_f32 v119, v122, v123
    s_add_u32 s56, s54, s62
    buffer_store_dwordx4 v[116:119], v188, s[24:27], s56 offen sc1
cB_pub:
    s_lshl_b32 s54, s33, 1
    s_add_u32 s54, s54, s40
    s_lshl_b32 s54, s54, 6
    s_lshl_b32 s55, s34, 1
    s_add_u32 s55, s55, s41
    s_lshl_b32 s55, s55, 2
    s_add_u32 s54, s54, s55
    s_add_u32 s54, s54, 0xb29000
    v_mov_b32 v230, s54
    v_mov_b32 v231, s73
    s_waitcnt vmcnt(0)
    s_mov_b64 exec, 1
    buffer_store_dword v231, v230, s[24:27], 0 offen sc1
    s_mov_b64 exec, -1
    s_barrier
    s_barrier
p2_compute:
    s_nop 1
    s_mov_b32 s28, s88
    s_and_b32 s29, s89, 0xffff
    s_mov_b32 s30, 0x280000
    s_mov_b32 s31, 0x20000
    v_lshrrev_b32 v122, 4, v0
    v_and_b32 v123, 15, v0
    v_lshlrev_b32 v126, 4, v0
    s_lshl_b32 s56, s36, 10
    v_add_u32 v120, s56, v126
    v_add_u32 v121, 61440, v126
    s_lshl_b32 s56, s82, 6
    s_lshl_b32 s57, s36, 4
    s_add_u32 s56, s56, s57
    v_add_u32 v126, s56, v123
    v_mul_u32_u24 v126, 0x500, v126
    s_mul_i32 s56, s83, 160
    v_lshlrev_b32 v127, 3, v122
    v_add3_u32 v124, v126, v127, s56
    v_mov_b32 v4, 0
    v_mov_b32 v5, 0
    v_mov_b32 v6, 0
    v_mov_b32 v7, 0
    v_mov_b32 v8, 0
    v_mov_b32 v9, 0
    v_mov_b32 v10, 0
    v_mov_b32 v11, 0
    v_mov_b32 v12, 0
    v_mov_b32 v13, 0
    v_mov_b32 v14, 0
    v_mov_b32 v15, 0
    v_mov_b32 v16, 0
    v_mov_b32 v17, 0
    v_mov_b32 v18, 0
    v_mov_b32 v19, 0
    v_mov_b32 v20, 0
    v_mov_b32 v21, 0
    v_mov_b32 v22, 0
    v_mov_b32 v23, 0
    v_mov_b32 v24, 0
    v_mov_b32 v25, 0
    v_mov_b32 v26, 0
    v_mov_b32 v27, 0
    v_mov_b32 v28, 0
    v_mov_b32 v29, 0
    v_mov_b32 v30, 0
    v_mov_b32 v31, 0
    v_mov_b32 v32, 0
    v_mov_b32 v33, 0
    v_mov_b32 v34, 0
    v_mov_b32 v35, 0
    v_mov_b32 v36, 0
    v_mov_b32 v37, 0
    v_mov_b32 v38, 0
    v_mov_b32 v39, 0
    v_mov_b32 v40, 0
    v_mov_b32 v41, 0
    v_mov_b32 v42, 0
    v_mov_b32 v43, 0
    s_mov_b32 s61, 0
    s_mov_b32 s63, 0
    v_lshrrev_b32 v126, 1, v122
    v_lshl_add_u32 v126, v126, 4, v123
    v_lshlrev_b32 v126, 4, v126
    v_and_b32 v127, 1, v122
    v_lshl_add_u32 v126, v127, 3, v126
    s_lshl_b32 s56, s36, 10
    v_add_u32 v130, s56, v126
    s_barrier
    ds_read_b128 v[44:47], v120 offset:0
    ds_read_b128 v[60:63], v121 offset:0
    ds_read_b128 v[64:67], v121 offset:1024
    ds_read_b128 v[68:71], v121 offset:2048
    ds_read_b128 v[48:51], v120 offset:4096
    ds_read_b128 v[72:75], v121 offset:3072
    ds_read_b128 v[52:55], v120 offset:8192
    ds_read_b128 v[76:79], v121 offset:4096
    ds_read_b128 v[80:83], v121 offset:5120
    ds_read_b128 v[84:87], v121 offset:6144
    s_mov_b32 s70, 0
p2_loop_60:
    s_waitcnt lgkmcnt(8)
    v_mfma_f32_16x16x32_bf16 v[24:27], v[60:63], v[44:47], v[24:27]
    ds_read_b128 v[56:59], v120 offset:12288
    ds_read_b128 v[88:91], v121 offset:7168
    s_waitcnt lgkmcnt(9)
    v_mfma_f32_16x16x32_bf16 v[28:31], v[64:67], v[44:47], v[28:31]
    ds_read_b128 v[92:95], v121 offset:8192
    s_add_u32 s61, s61, 1
    s_cmp_eq_u32 s61, 3
    s_cselect_b32 s61, 0, s61
    s_waitcnt lgkmcnt(9)
    v_mfma_f32_16x16x32_bf16 v[32:35], v[68:71], v[44:47], v[32:35]
    ds_read_b128 v[96:99], v121 offset:9216
    s_mov_b32 s62, 16384
    s_cselect_b32 s62, 0xffff8000, s62
    s_waitcnt lgkmcnt(8)
    v_mfma_f32_16x16x32_bf16 v[36:39], v[72:75], v[44:47], v[36:39]
    ds_read_b128 v[60:63], v121 offset:10240
    s_add_u32 s63, s63, 1
    s_cmp_eq_u32 s63, 4
    s_cselect_b32 s63, 0, s63
    s_waitcnt lgkmcnt(7)
    v_mfma_f32_16x16x32_bf16 v[40:43], v[76:79], v[44:47], v[40:43]
    ds_read_b128 v[64:67], v121 offset:11264
    s_mov_b32 s64, 20480
    s_cselect_b32 s64, 0xffff1000, s64
    s_waitcnt lgkmcnt(7)
    v_mfma_f32_16x16x32_bf16 v[24:27], v[80:83], v[48:51], v[24:27]
    ds_read_b128 v[68:71], v121 offset:12288
    s_waitcnt lgkmcnt(7)
    v_mfma_f32_16x16x32_bf16 v[28:31], v[84:87], v[48:51], v[28:31]
    ds_read_b128 v[72:75], v121 offset:13312
    s_waitcnt lgkmcnt(6)
    v_mfma_f32_16x16x32_bf16 v[32:35], v[88:91], v[48:51], v[32:35]
    ds_read_b128 v[76:79], v121 offset:14336
    s_waitcnt lgkmcnt(6)
    v_mfma_f32_16x16x32_bf16 v[36:39], v[92:95], v[48:51], v[36:39]
    ds_read_b128 v[80:83], v121 offset:15360
    s_waitcnt lgkmcnt(6)
    v_mfma_f32_16x16x32_bf16 v[40:43], v[96:99], v[48:51], v[40:43]
    ds_read_b128 v[84:87], v121 offset:16384
    s_waitcnt lgkmcnt(6)
    v_mfma_f32_16x16x32_bf16 v[24:27], v[60:63], v[52:55], v[24:27]
    ds_read_b128 v[88:91], v121 offset:17408
    s_waitcnt lgkmcnt(6)
    v_mfma_f32_16x16x32_bf16 v[28:31], v[64:67], v[52:55], v[28:31]
    ds_read_b128 v[92:95], v121 offset:18432
    s_waitcnt lgkmcnt(6)
    v_mfma_f32_16x16x32_bf16 v[32:35], v[68:71], v[52:55], v[32:35]
    ds_read_b128 v[96:99], v121 offset:19456
    v_add_u32 v130, s62, v130
    s_waitcnt lgkmcnt(6)
    v_mfma_f32_16x16x32_bf16 v[36:39], v[72:75], v[52:55], v[36:39]
    v_add_u32 v120, s62, v120
    v_add_u32 v121, s64, v121
    s_waitcnt lgkmcnt(5)
    v_mfma_f32_16x16x32_bf16 v[40:43], v[76:79], v[52:55], v[40:43]
    s_waitcnt lgkmcnt(0)
    s_barrier
    v_mfma_f32_16x16x32_bf16 v[24:27], v[80:83], v[56:59], v[24:27]
    ds_read_b128 v[44:47], v120 offset:0
    ds_read_b128 v[60:63], v121 offset:0
    ds_read_b128 v[64:67], v121 offset:1024
    v_mfma_f32_16x16x32_bf16 v[28:31], v[84:87], v[56:59], v[28:31]
    ds_read_b128 v[68:71], v121 offset:2048
    ds_read_b128 v[48:51], v120 offset:4096
    ds_read_b128 v[72:75], v121 offset:3072
    v_mfma_f32_16x16x32_bf16 v[32:35], v[88:91], v[56:59], v[32:35]
    ds_read_b128 v[52:55], v120 offset:8192
    ds_read_b128 v[76:79], v121 offset:4096
    ds_read_b128 v[80:83], v121 offset:5120
    v_mfma_f32_16x16x32_bf16 v[36:39], v[92:95], v[56:59], v[36:39]
    ds_read_b128 v[84:87], v121 offset:6144
    v_mfma_f32_16x16x32_bf16 v[40:43], v[96:99], v[56:59], v[40:43]
    s_add_u32 s70, s70, 1
    s_cmp_lt_u32 s70, 11
    s_cbranch_scc1 p2_loop_60
    s_waitcnt lgkmcnt(8)
    v_mfma_f32_16x16x32_bf16 v[24:27], v[60:63], v[44:47], v[24:27]
    ds_read_b128 v[56:59], v120 offset:12288
    ds_read_b128 v[88:91], v121 offset:7168
    s_waitcnt lgkmcnt(9)
    v_mfma_f32_16x16x32_bf16 v[28:31], v[64:67], v[44:47], v[28:31]
    ds_read_b128 v[92:95], v121 offset:8192
    s_add_u32 s61, s61, 1
    s_cmp_eq_u32 s61, 3
    s_cselect_b32 s61, 0, s61
    s_waitcnt lgkmcnt(9)
    v_mfma_f32_16x16x32_bf16 v[32:35], v[68:71], v[44:47], v[32:35]
    ds_read_b128 v[96:99], v121 offset:9216
    s_mov_b32 s62, 16384
    s_cselect_b32 s62, 0xffff8000, s62
    s_waitcnt lgkmcnt(8)
    v_mfma_f32_16x16x32_bf16 v[36:39], v[72:75], v[44:47], v[36:39]
    ds_read_b128 v[60:63], v121 offset:10240
    s_add_u32 s63, s63, 1
    s_cmp_eq_u32 s63, 4
    s_cselect_b32 s63, 0, s63
    s_waitcnt lgkmcnt(7)
    v_mfma_f32_16x16x32_bf16 v[40:43], v[76:79], v[44:47], v[40:43]
    ds_read_b128 v[64:67], v121 offset:11264
    s_mov_b32 s64, 20480
    s_cselect_b32 s64, 0xffff1000, s64
    s_waitcnt lgkmcnt(7)
    v_mfma_f32_16x16x32_bf16 v[24:27], v[80:83], v[48:51], v[24:27]
    ds_read_b128 v[68:71], v121 offset:12288
    s_waitcnt lgkmcnt(7)
    v_mfma_f32_16x16x32_bf16 v[28:31], v[84:87], v[48:51], v[28:31]
    ds_read_b128 v[72:75], v121 offset:13312
    s_waitcnt lgkmcnt(6)
    v_mfma_f32_16x16x32_bf16 v[32:35], v[88:91], v[48:51], v[32:35]
    ds_read_b128 v[76:79], v121 offset:14336
    s_waitcnt lgkmcnt(6)
    v_mfma_f32_16x16x32_bf16 v[36:39], v[92:95], v[48:51], v[36:39]
    ds_read_b128 v[80:83], v121 offset:15360
    s_waitcnt lgkmcnt(6)
    v_mfma_f32_16x16x32_bf16 v[40:43], v[96:99], v[48:51], v[40:43]
    ds_read_b128 v[84:87], v121 offset:16384
    s_waitcnt lgkmcnt(6)
    v_mfma_f32_16x16x32_bf16 v[24:27], v[60:63], v[52:55], v[24:27]
    ds_read_b128 v[88:91], v121 offset:17408
    s_waitcnt lgkmcnt(6)
    v_mfma_f32_16x16x32_bf16 v[28:31], v[64:67], v[52:55], v[28:31]
    ds_read_b128 v[92:95], v121 offset:18432
    s_waitcnt lgkmcnt(6)
    v_mfma_f32_16x16x32_bf16 v[32:35], v[68:71], v[52:55], v[32:35]
    ds_read_b128 v[96:99], v121 offset:19456
    v_add_u32 v130, s62, v130
    s_waitcnt lgkmcnt(6)
    v_mfma_f32_16x16x32_bf16 v[36:39], v[72:75], v[52:55], v[36:39]
    v_add_u32 v120, s62, v120
    v_add_u32 v121, s64, v121
    s_waitcnt lgkmcnt(5)
    v_mfma_f32_16x16x32_bf16 v[40:43], v[76:79], v[52:55], v[40:43]
    s_waitcnt lgkmcnt(0)
    s_barrier
    v_mfma_f32_16x16x32_bf16 v[24:27], v[80:83], v[56:59], v[24:27]
    ds_read_b64 v[44:45], v130 offset:0
    ds_read_b64 v[46:47], v130 offset:512
    ds_read_b128 v[60:63], v121 offset:0
    v_mfma_f32_16x16x32_bf16 v[28:31], v[84:87], v[56:59], v[28:31]
    ds_read_b128 v[64:67], v121 offset:1024
    ds_read_b128 v[68:71], v121 offset:2048
    ds_read_b64 v[48:49], v130 offset:4096
    v_mfma_f32_16x16x32_bf16 v[32:35], v[88:91], v[56:59], v[32:35]
    ds_read_b64 v[50:51], v130 offset:4608
    ds_read_b128 v[72:75], v121 offset:3072
    ds_read_b64 v[52:53], v130 offset:8192
    v_mfma_f32_16x16x32_bf16 v[36:39], v[92:95], v[56:59], v[36:39]
    ds_read_b64 v[54:55], v130 offset:8704
    ds_read_b128 v[76:79], v121 offset:4096
    ds_read_b128 v[80:83], v121 offset:5120
    v_mfma_f32_16x16x32_bf16 v[40:43], v[96:99], v[56:59], v[40:43]
    ds_read_b128 v[84:87], v121 offset:6144
    s_mov_b32 s70, 0
p2_loop_62:
    s_waitcnt lgkmcnt(10)
    v_mfma_f32_16x16x32_bf16 v[4:7], v[60:63], v[44:47], v[4:7]
    ds_read_b64 v[56:57], v130 offset:12288
    ds_read_b64 v[58:59], v130 offset:12800
    s_waitcnt lgkmcnt(11)
    v_mfma_f32_16x16x32_bf16 v[8:11], v[64:67], v[44:47], v[8:11]
    ds_read_b128 v[88:91], v121 offset:7168
    ds_read_b128 v[92:95], v121 offset:8192
    s_add_u32 s61, s61, 1
    s_cmp_eq_u32 s61, 3
    s_cselect_b32 s61, 0, s61
    s_waitcnt lgkmcnt(12)
    v_mfma_f32_16x16x32_bf16 v[12:15], v[68:71], v[44:47], v[12:15]
    ds_read_b128 v[96:99], v121 offset:9216
    s_mov_b32 s62, 16384
    s_cselect_b32 s62, 0xffff8000, s62
    s_waitcnt lgkmcnt(10)
    v_mfma_f32_16x16x32_bf16 v[16:19], v[72:75], v[44:47], v[16:19]
    ds_read_b128 v[60:63], v121 offset:10240
    s_add_u32 s63, s63, 1
    s_cmp_eq_u32 s63, 4
    s_cselect_b32 s63, 0, s63
    s_waitcnt lgkmcnt(8)
    v_mfma_f32_16x16x32_bf16 v[20:23], v[76:79], v[44:47], v[20:23]
    ds_read_b128 v[64:67], v121 offset:11264
    s_mov_b32 s64, 20480
    s_cselect_b32 s64, 0xffff1000, s64
    s_waitcnt lgkmcnt(8)
    v_mfma_f32_16x16x32_bf16 v[4:7], v[80:83], v[48:51], v[4:7]
    ds_read_b128 v[68:71], v121 offset:12288
    s_waitcnt lgkmcnt(8)
    v_mfma_f32_16x16x32_bf16 v[8:11], v[84:87], v[48:51], v[8:11]
    ds_read_b128 v[72:75], v121 offset:13312
    s_waitcnt lgkmcnt(6)
    v_mfma_f32_16x16x32_bf16 v[12:15], v[88:91], v[48:51], v[12:15]
    ds_read_b128 v[76:79], v121 offset:14336
    s_waitcnt lgkmcnt(6)
    v_mfma_f32_16x16x32_bf16 v[16:19], v[92:95], v[48:51], v[16:19]
    ds_read_b128 v[80:83], v121 offset:15360
    s_waitcnt lgkmcnt(6)
    v_mfma_f32_16x16x32_bf16 v[20:23], v[96:99], v[48:51], v[20:23]
    ds_read_b128 v[84:87], v121 offset:16384
    s_waitcnt lgkmcnt(6)
    v_mfma_f32_16x16x32_bf16 v[4:7], v[60:63], v[52:55], v[4:7]
    ds_read_b128 v[88:91], v121 offset:17408
    s_waitcnt lgkmcnt(6)
    v_mfma_f32_16x16x32_bf16 v[8:11], v[64:67], v[52:55], v[8:11]
    ds_read_b128 v[92:95], v121 offset:18432
    s_waitcnt lgkmcnt(6)
    v_mfma_f32_16x16x32_bf16 v[12:15], v[68:71], v[52:55], v[12:15]
    ds_read_b128 v[96:99], v121 offset:19456
    v_add_u32 v130, s62, v130
    s_waitcnt lgkmcnt(6)
    v_mfma_f32_16x16x32_bf16 v[16:19], v[72:75], v[52:55], v[16:19]
    v_add_u32 v120, s62, v120
    v_add_u32 v121, s64, v121
    s_waitcnt lgkmcnt(5)
    v_mfma_f32_16x16x32_bf16 v[20:23], v[76:79], v[52:55], v[20:23]
    s_waitcnt lgkmcnt(0)
    s_barrier
    v_mfma_f32_16x16x32_bf16 v[4:7], v[80:83], v[56:59], v[4:7]
    ds_read_b64 v[44:45], v130 offset:0
    ds_read_b64 v[46:47], v130 offset:512
    ds_read_b128 v[60:63], v121 offset:0
    v_mfma_f32_16x16x32_bf16 v[8:11], v[84:87], v[56:59], v[8:11]
    ds_read_b128 v[64:67], v121 offset:1024
    ds_read_b128 v[68:71], v121 offset:2048
    ds_read_b64 v[48:49], v130 offset:4096
    v_mfma_f32_16x16x32_bf16 v[12:15], v[88:91], v[56:59], v[12:15]
    ds_read_b64 v[50:51], v130 offset:4608
    ds_read_b128 v[72:75], v121 offset:3072
    ds_read_b64 v[52:53], v130 offset:8192
    v_mfma_f32_16x16x32_bf16 v[16:19], v[92:95], v[56:59], v[16:19]
    ds_read_b64 v[54:55], v130 offset:8704
    ds_read_b128 v[76:79], v121 offset:4096
    ds_read_b128 v[80:83], v121 offset:5120
    v_mfma_f32_16x16x32_bf16 v[20:23], v[96:99], v[56:59], v[20:23]
    ds_read_b128 v[84:87], v121 offset:6144
    s_add_u32 s70, s70, 1
    s_cmp_lt_u32 s70, 5
    s_cbranch_scc1 p2_loop_62
    s_waitcnt lgkmcnt(0)
    v_mul_u32_u24 v126, 160, v123
    v_lshlrev_b32 v127, 3, v122
    s_mul_i32 s56, s36, 3072
    s_add_u32 s56, s56, 143360
    v_add3_u32 v126, v126, v127, s56
    v_add_u32 v127, 0x26000, v127
    ds_read_b64 v[110:111], v127 offset:0
    ds_read_b64 v[112:113], v127 offset:32
    ds_read_b64 v[114:115], v127 offset:64
    ds_read_b64 v[116:117], v127 offset:96
    ds_read_b64 v[118:119], v127 offset:128
    ds_read_b64 v[100:101], v126 offset:0
    ds_read_b64 v[102:103], v126 offset:32
    ds_read_b64 v[104:105], v126 offset:64
    ds_read_b64 v[106:107], v126 offset:96
    ds_read_b64 v[108:109], v126 offset:128
    s_mov_b32 s56, 0xbfb8aa3b
    s_waitcnt lgkmcnt(5)
    v_lshlrev_b32 v60, 16, v110
    v_and_b32 v61, 0xffff0000, v110
    v_lshlrev_b32 v62, 16, v111
    v_and_b32 v63, 0xffff0000, v111
    v_lshlrev_b32 v64, 16, v112
    v_and_b32 v65, 0xffff0000, v112
    v_lshlrev_b32 v66, 16, v113
    v_and_b32 v67, 0xffff0000, v113
    v_lshlrev_b32 v68, 16, v114
    v_and_b32 v69, 0xffff0000, v114
    v_lshlrev_b32 v70, 16, v115
    v_and_b32 v71, 0xffff0000, v115
    v_lshlrev_b32 v72, 16, v116
    v_and_b32 v73, 0xffff0000, v116
    v_lshlrev_b32 v74, 16, v117
    v_and_b32 v75, 0xffff0000, v117
    v_lshlrev_b32 v76, 16, v118
    v_and_b32 v77, 0xffff0000, v118
    v_lshlrev_b32 v78, 16, v119
    v_and_b32 v79, 0xffff0000, v119
    v_pk_add_f32 v[24:25], v[24:25], v[60:61]
    v_pk_add_f32 v[26:27], v[26:27], v[62:63]
    v_mul_f32 v80, s56, v24
    v_mul_f32 v81, s56, v25
    v_mul_f32 v82, s56, v26
    v_mul_f32 v83, s56, v27
    v_exp_f32 v80, v80
    v_exp_f32 v81, v81
    v_exp_f32 v82, v82
    v_exp_f32 v83, v83
    v_pk_add_f32 v[28:29], v[28:29], v[64:65]
    v_pk_add_f32 v[30:31], v[30:31], v[66:67]
    v_mul_f32 v84, s56, v28
    v_mul_f32 v85, s56, v29
    v_mul_f32 v86, s56, v30
    v_mul_f32 v87, s56, v31
    v_exp_f32 v84, v84
    v_exp_f32 v85, v85
    v_exp_f32 v86, v86
    v_exp_f32 v87, v87
    v_pk_add_f32 v[32:33], v[32:33], v[68:69]
    v_pk_add_f32 v[34:35], v[34:35], v[70:71]
    v_mul_f32 v88, s56, v32
    v_mul_f32 v89, s56, v33
    v_mul_f32 v90, s56, v34
    v_mul_f32 v91, s56, v35
    v_exp_f32 v88, v88
    v_exp_f32 v89, v89
    v_exp_f32 v90, v90
    v_exp_f32 v91, v91
    v_pk_add_f32 v[36:37], v[36:37], v[72:73]
    v_pk_add_f32 v[38:39], v[38:39], v[74:75]
    v_mul_f32 v92, s56, v36
    v_mul_f32 v93, s56, v37
    v_mul_f32 v94, s56, v38
    v_mul_f32 v95, s56, v39
    v_exp_f32 v92, v92
    v_exp_f32 v93, v93
    v_exp_f32 v94, v94
    v_exp_f32 v95, v95
    v_pk_add_f32 v[40:41], v[40:41], v[76:77]
    v_pk_add_f32 v[42:43], v[42:43], v[78:79]
    v_mul_f32 v96, s56, v40
    v_mul_f32 v97, s56, v41
    v_mul_f32 v98, s56, v42
    v_mul_f32 v99, s56, v43
    v_exp_f32 v96, v96
    v_exp_f32 v97, v97
    v_exp_f32 v98, v98
    v_exp_f32 v99, v99
    s_waitcnt lgkmcnt(0)
    v_add_f32 v80, 1.0, v80
    v_add_f32 v81, 1.0, v81
    v_add_f32 v82, 1.0, v82
    v_add_f32 v83, 1.0, v83
    v_rcp_f32 v80, v80
    v_rcp_f32 v81, v81
    v_rcp_f32 v82, v82
    v_rcp_f32 v83, v83
    v_pk_mul_f32 v[24:25], v[24:25], v[4:5]
    v_pk_mul_f32 v[26:27], v[26:27], v[6:7]
    v_lshlrev_b32 v60, 16, v100
    v_and_b32 v61, 0xffff0000, v100
    v_lshlrev_b32 v62, 16, v101
    v_and_b32 v63, 0xffff0000, v101
    v_pk_fma_f32 v[24:25], v[24:25], v[80:81], v[60:61]
    v_pk_fma_f32 v[26:27], v[26:27], v[82:83], v[62:63]
    v_cvt_pk_bf16_f32 v24, v24, v25
    v_cvt_pk_bf16_f32 v25, v26, v27
    buffer_store_dwordx2 v[24:25], v124, s[28:31], 0 offen offset:0
    v_add_f32 v84, 1.0, v84
    v_add_f32 v85, 1.0, v85
    v_add_f32 v86, 1.0, v86
    v_add_f32 v87, 1.0, v87
    v_rcp_f32 v84, v84
    v_rcp_f32 v85, v85
    v_rcp_f32 v86, v86
    v_rcp_f32 v87, v87
    v_pk_mul_f32 v[28:29], v[28:29], v[8:9]
    v_pk_mul_f32 v[30:31], v[30:31], v[10:11]
    v_lshlrev_b32 v64, 16, v102
    v_and_b32 v65, 0xffff0000, v102
    v_lshlrev_b32 v66, 16, v103
    v_and_b32 v67, 0xffff0000, v103
    v_pk_fma_f32 v[28:29], v[28:29], v[84:85], v[64:65]
    v_pk_fma_f32 v[30:31], v[30:31], v[86:87], v[66:67]
    v_cvt_pk_bf16_f32 v28, v28, v29
    v_cvt_pk_bf16_f32 v29, v30, v31
    buffer_store_dwordx2 v[28:29], v124, s[28:31], 0 offen offset:32
    v_add_f32 v88, 1.0, v88
    v_add_f32 v89, 1.0, v89
    v_add_f32 v90, 1.0, v90
    v_add_f32 v91, 1.0, v91
    v_rcp_f32 v88, v88
    v_rcp_f32 v89, v89
    v_rcp_f32 v90, v90
    v_rcp_f32 v91, v91
    v_pk_mul_f32 v[32:33], v[32:33], v[12:13]
    v_pk_mul_f32 v[34:35], v[34:35], v[14:15]
    v_lshlrev_b32 v68, 16, v104
    v_and_b32 v69, 0xffff0000, v104
    v_lshlrev_b32 v70, 16, v105
    v_and_b32 v71, 0xffff0000, v105
    v_pk_fma_f32 v[32:33], v[32:33], v[88:89], v[68:69]
    v_pk_fma_f32 v[34:35], v[34:35], v[90:91], v[70:71]
    v_cvt_pk_bf16_f32 v32, v32, v33
    v_cvt_pk_bf16_f32 v33, v34, v35
    buffer_store_dwordx2 v[32:33], v124, s[28:31], 0 offen offset:64
    v_add_f32 v92, 1.0, v92
    v_add_f32 v93, 1.0, v93
    v_add_f32 v94, 1.0, v94
    v_add_f32 v95, 1.0, v95
    v_rcp_f32 v92, v92
    v_rcp_f32 v93, v93
    v_rcp_f32 v94, v94
    v_rcp_f32 v95, v95
    v_pk_mul_f32 v[36:37], v[36:37], v[16:17]
    v_pk_mul_f32 v[38:39], v[38:39], v[18:19]
    v_lshlrev_b32 v72, 16, v106
    v_and_b32 v73, 0xffff0000, v106
    v_lshlrev_b32 v74, 16, v107
    v_and_b32 v75, 0xffff0000, v107
    v_pk_fma_f32 v[36:37], v[36:37], v[92:93], v[72:73]
    v_pk_fma_f32 v[38:39], v[38:39], v[94:95], v[74:75]
    v_cvt_pk_bf16_f32 v36, v36, v37
    v_cvt_pk_bf16_f32 v37, v38, v39
    buffer_store_dwordx2 v[36:37], v124, s[28:31], 0 offen offset:96
    v_add_f32 v96, 1.0, v96
    v_add_f32 v97, 1.0, v97
    v_add_f32 v98, 1.0, v98
    v_add_f32 v99, 1.0, v99
    v_rcp_f32 v96, v96
    v_rcp_f32 v97, v97
    v_rcp_f32 v98, v98
    v_rcp_f32 v99, v99
    v_pk_mul_f32 v[40:41], v[40:41], v[20:21]
    v_pk_mul_f32 v[42:43], v[42:43], v[22:23]
    v_lshlrev_b32 v76, 16, v108
    v_and_b32 v77, 0xffff0000, v108
    v_lshlrev_b32 v78, 16, v109
    v_and_b32 v79, 0xffff0000, v109
    v_pk_fma_f32 v[40:41], v[40:41], v[96:97], v[76:77]
    v_pk_fma_f32 v[42:43], v[42:43], v[98:99], v[78:79]
    v_cvt_pk_bf16_f32 v40, v40, v41
    v_cvt_pk_bf16_f32 v41, v42, v43
    buffer_store_dwordx2 v[40:41], v124, s[28:31], 0 offen offset:128
    s_endpgm
k_exit:
    s_endpgm

code_end:
.section .rodata,"a"
.p2align 6
.amdhsa_kernel recurrent_scan__sliding_local_dilated__dense_activation_squared_relu__prompt_kernel
  .amdhsa_next_free_vgpr 256
  .amdhsa_next_free_sgpr 102
  .amdhsa_accum_offset 256
  .amdhsa_group_segment_fixed_size 0
  .amdhsa_kernarg_size 88
  .amdhsa_user_sgpr_count 2
  .amdhsa_user_sgpr_kernarg_segment_ptr 1
  .amdhsa_system_sgpr_workgroup_id_x 1
.end_amdhsa_kernel
```
